```python
import torch

def _softmax(x, axis=-1):
    return torch.softmax(x, dim=axis)
def _gelu(x):
    return torch.nn.functional.gelu(x, approximate="tanh")
def _silu(x):
    return torch.nn.functional.silu(x)
def _sigmoid(x):
    return torch.sigmoid(x)
def _layernorm(x, axis=-1, eps=1e-5):
    m = x.mean(dim=axis, keepdim=True)
    v = x.var(dim=axis, keepdim=True, unbiased=False)
    return (x - m) / torch.sqrt(v + eps)
def _scatter_add(tgt, idx, src, axis=0):
    return tgt.clone().index_add_(axis, idx, src)
def _segment_sum(src, seg, n):
    out = torch.zeros((n,) + src.shape[1:], dtype=src.dtype)
    return out.index_add_(0, seg, src)
def _pad(x, pw):
    flat = tuple(v for pair in reversed(pw) for v in pair)
    return torch.nn.functional.pad(x, flat)

kernel_name = 'standalone__normalfloat_lut_codebook_lookup__prompt'

def setup_inputs():

    _w = (lambda a: (lambda t: t.to(torch.bfloat16) if t.is_floating_point() else t)(torch.as_tensor(a)))
    B, S, D, F = 1, 2048, 1024, 3584
    G = 64 if 64 > 0 else D
    D = (D // G) * G
    ng = D // G
    nf4 = torch.tensor([
        -1.0, -0.6961928009986877, -0.5250730514526367, -0.39491748809814453,
        -0.28444138169288635, -0.18477343022823334, -0.09105003625154495, 0.0,
        0.07958029955625534, 0.16093020141124725, 0.24611230194568634, 0.33791524171829224,
        0.44070982933044434, 0.5626170039176941, 0.7229568362236023, 1.0
    ], dtype=float)
    qw = torch.randint(0, 16, (D, F)).to(torch.int64)
    absmax = (torch.abs((lambda *s: torch.randn(*s, dtype=torch.bfloat16) * 0.05)(ng, F)) + 0.01).to(float)
    return {
        "x": _w((lambda *s: torch.randn(*s, dtype=torch.bfloat16) * 0.05)(B, S, D)),
        "qw": _w(qw),
        "codebook": _w(nf4),
        "absmax": _w(absmax),
    }

def reference(x, qw, codebook, absmax):
    B, S, D = x.shape
    ng, F = absmax.shape
    G = D // ng
    w_nf = codebook[qw]
    s = (lambda x, n, axis: torch.repeat_interleave(x, n, dim=axis))(absmax, G, axis=0)
    w = (lambda x, dt: x.to(dt))(w_nf * s, x.dtype)
    return torch.einsum("bsd,df->bsf", x, w)
```

```asm
; @launch grid=(256,1,1) block=(256,1,1) lds=163840
.amdgcn_target "amdgcn-amd-amdhsa--gfx950"
.text
.globl standalone__normalfloat_lut_codebook_lookup__prompt_kernel
.p2align 12
.p2align 8
.type standalone__normalfloat_lut_codebook_lookup__prompt_kernel,@function
standalone__normalfloat_lut_codebook_lookup__prompt_kernel:
    s_cmp_ge_u32 s2, 256
    s_cbranch_scc1 L_end
    s_load_dwordx2 s[24:25], s[0:1], 8
    s_load_dwordx2 s[32:33], s[0:1], 16
    s_load_dwordx2 s[28:29], s[0:1], 24
    s_load_dwordx2 s[44:45], s[0:1], 40
    s_load_dwordx2 s[20:21], s[0:1], 0
    s_load_dwordx2 s[40:41], s[0:1], 48
    s_load_dwordx2 s[36:37], s[0:1], 32
    s_memrealtime s[54:55]
    v_lshrrev_b32 v1, 6, v0
    v_and_b32 v0, 63, v0
    s_and_b32 s52, s2, 7
    s_lshr_b32 s53, s2, 3
    v_readfirstlane_b32 s48, v1
    s_and_b32 s49, s53, 15
    s_lshl_b32 s50, s52, 1
    s_lshr_b32 s58, s53, 4
    s_add_u32 s50, s50, s58
    s_mov_b32 s51, s49
    v_and_b32 v2, 15, v0
    v_lshrrev_b32 v3, 4, v0
    s_mov_b32 s26, 14680064
    s_mov_b32 s27, 0x20000
    s_mov_b32 s34, 32
    s_mov_b32 s35, 0x20000
    s_mov_b32 s30, 114688
    s_mov_b32 s31, 0x20000
    s_mov_b32 s46, 256
    s_mov_b32 s47, 0x20000
    s_mov_b32 s22, 4194304
    s_mov_b32 s23, 0x20000
    s_mov_b32 s42, 33554432
    s_mov_b32 s43, 0x20000
    s_mov_b32 s38, 14680064
    s_mov_b32 s39, 0x20000
    s_lshr_b32 s76, s48, 1
    s_and_b32 s58, s48, 1
    s_lshl_b32 s52, s51, 1
    s_add_u32 s52, s52, s76
    s_mul_i32 s52, s52, 458752
    v_mul_u32_u24 v4, 114688, v3
    v_add_u32 v4, s52, v4
    s_mul_i32 s52, s50, 512
    s_lshl_b32 s53, s58, 8
    s_add_u32 s52, s52, s53
    v_lshl_add_u32 v19, v2, 4, v4
    v_add_u32 v19, s52, v19
    s_mul_i32 s7, s51, 7168
    s_lshr_b32 s52, s52, 1
    v_lshl_add_u32 v28, v2, 3, s52
    v_lshl_add_u32 v21, v2, 3, v4
    v_lshlrev_b32 v4, 1, v0
    s_mov_b32 s10, 94208
    s_waitcnt lgkmcnt(0)
    buffer_load_ushort v1, v4, s[32:35], 0 offen
    buffer_load_dwordx2 v[24:25], v28, s[28:31], s7 offen
    buffer_load_dwordx4 v[64:67], v19, s[24:27], 0 offen nt
    s_mov_b32 s52, 14336
    buffer_load_dwordx4 v[68:71], v19, s[24:27], s52 offen nt
    s_mov_b32 s52, 28672
    buffer_load_dwordx4 v[72:75], v19, s[24:27], s52 offen nt
    s_mov_b32 s52, 43008
    buffer_load_dwordx4 v[76:79], v19, s[24:27], s52 offen nt
    s_mov_b32 s52, 57344
    buffer_load_dwordx4 v[80:83], v19, s[24:27], s52 offen nt
    s_mov_b32 s52, 71680
    buffer_load_dwordx4 v[84:87], v19, s[24:27], s52 offen nt
    s_mov_b32 s52, 86016
    buffer_load_dwordx4 v[88:91], v19, s[24:27], s52 offen nt
    s_mov_b32 s52, 100352
    buffer_load_dwordx4 v[92:95], v19, s[24:27], s52 offen nt
    s_or_b32 s52, s2, s48
    s_cmp_lg_u32 s52, 0
    s_cbranch_scc1 L_notag
    s_or_b32 s54, s54, 1
    v_mov_b32 v144, s54
    v_mov_b32 v145, s55
    s_mov_b64 exec, 1
    buffer_store_dwordx2 v[144:145], off, s[44:47], 0 sc1
    s_mov_b64 exec, -1
L_notag:
    s_getpc_b64 s[8:9]
    L_pc:
    s_lshr_b32 s52, s2, 3
    s_lshl_b32 s52, s52, 2
    s_add_u32 s52, s52, s48
    s_mul_i32 s52, s52, 256
    v_lshl_add_u32 v148, v0, 7, s52
    v_min_u32 v148, L_end-L_pc, v148
    s_mov_b64 exec, 3
    global_load_dword v148, v148, s[8:9]
    s_mov_b64 exec, -1
    s_and_b32 s58, s48, 1
    s_mul_i32 s52, s50, 256
    s_lshl_b32 s53, s58, 7
    s_add_u32 s52, s52, s53
    s_add_u32 s52, s52, 8192
    v_add_u32 v20, s52, v21
    s_lshr_b32 s52, s52, 1
    v_lshl_add_u32 v29, v2, 2, s52
    s_mul_i32 s52, s50, 128
    s_lshl_b32 s53, s58, 2
    s_add_u32 s52, s52, s53
    s_add_u32 s52, s52, 12288
    v_add_u32 v21, s52, v21
    s_lshr_b32 s52, s52, 1
    v_lshl_add_u32 v30, v2, 2, s52
    buffer_load_dword v29, v29, s[28:31], s7 offen
    buffer_load_ushort v30, v30, s[28:31], s7 offen
    s_lshl_b32 s4, s48, 12
    s_lshl_b32 s5, s48, 11
    s_lshl_b32 s6, s48, 10
    s_mul_i32 s52, s50, 458752
    v_lshlrev_b32 v5, 4, v0
    v_add_u32 v6, 0x10000, v5
    s_add_u32 s53, s52, s4
    v_add_u32 v16, s53, v5
    s_add_u32 s53, s52, s5
    s_add_u32 s53, s53, 262144
    v_add_u32 v17, s53, v5
    s_add_u32 s53, s52, s6
    s_add_u32 s53, s53, 393216
    v_add_u32 v18, s53, v5
    s_lshl_b32 s60, s51, 12
    s_lshr_b32 s53, s50, 1
    s_mul_i32 s53, s53, 8192
    s_sub_u32 s52, s60, s53
    s_and_b32 s52, s52, 0xf000
    s_cmp_gt_u32 s52, 0
    s_cselect_b32 s61, 0, 1
    s_lshl_b32 s61, s61, 12
    s_add_u32 s61, s61, s53
    s_and_b32 s61, s61, 0xf000
    s_cmp_gt_u32 s52, 4096
    s_cselect_b32 s62, 1, 2
    s_lshl_b32 s62, s62, 12
    s_add_u32 s62, s62, s53
    s_and_b32 s62, s62, 0xf000
    s_cmp_gt_u32 s52, 8192
    s_cselect_b32 s63, 2, 3
    s_lshl_b32 s63, s63, 12
    s_add_u32 s63, s63, s53
    s_and_b32 s63, s63, 0xf000
    s_cmp_gt_u32 s52, 12288
    s_cselect_b32 s64, 3, 4
    s_lshl_b32 s64, s64, 12
    s_add_u32 s64, s64, s53
    s_and_b32 s64, s64, 0xf000
    s_cmp_gt_u32 s52, 16384
    s_cselect_b32 s65, 4, 5
    s_lshl_b32 s65, s65, 12
    s_add_u32 s65, s65, s53
    s_and_b32 s65, s65, 0xf000
    s_cmp_gt_u32 s52, 20480
    s_cselect_b32 s66, 5, 6
    s_lshl_b32 s66, s66, 12
    s_add_u32 s66, s66, s53
    s_and_b32 s66, s66, 0xf000
    s_cmp_gt_u32 s52, 24576
    s_cselect_b32 s67, 6, 7
    s_lshl_b32 s67, s67, 12
    s_add_u32 s67, s67, s53
    s_and_b32 s67, s67, 0xf000
    s_cmp_gt_u32 s52, 28672
    s_cselect_b32 s68, 7, 8
    s_lshl_b32 s68, s68, 12
    s_add_u32 s68, s68, s53
    s_and_b32 s68, s68, 0xf000
    s_cmp_gt_u32 s52, 32768
    s_cselect_b32 s69, 8, 9
    s_lshl_b32 s69, s69, 12
    s_add_u32 s69, s69, s53
    s_and_b32 s69, s69, 0xf000
    s_cmp_gt_u32 s52, 36864
    s_cselect_b32 s70, 9, 10
    s_lshl_b32 s70, s70, 12
    s_add_u32 s70, s70, s53
    s_and_b32 s70, s70, 0xf000
    s_cmp_gt_u32 s52, 40960
    s_cselect_b32 s71, 10, 11
    s_lshl_b32 s71, s71, 12
    s_add_u32 s71, s71, s53
    s_and_b32 s71, s71, 0xf000
    s_cmp_gt_u32 s52, 45056
    s_cselect_b32 s72, 11, 12
    s_lshl_b32 s72, s72, 12
    s_add_u32 s72, s72, s53
    s_and_b32 s72, s72, 0xf000
    s_cmp_gt_u32 s52, 49152
    s_cselect_b32 s73, 12, 13
    s_lshl_b32 s73, s73, 12
    s_add_u32 s73, s73, s53
    s_and_b32 s73, s73, 0xf000
    s_cmp_gt_u32 s52, 53248
    s_cselect_b32 s74, 13, 14
    s_lshl_b32 s74, s74, 12
    s_add_u32 s74, s74, s53
    s_and_b32 s74, s74, 0xf000
    s_cmp_gt_u32 s52, 57344
    s_cselect_b32 s75, 14, 15
    s_lshl_b32 s75, s75, 12
    s_add_u32 s75, s75, s53
    s_and_b32 s75, s75, 0xf000
    s_lshl_b32 s52, s49, 2
    s_add_u32 s52, s52, s48
    s_lshl_b32 s52, s52, 16
    v_lshrrev_b32 v4, 3, v0
    v_lshlrev_b32 v4, 11, v4
    v_add_u32 v4, s52, v4
    v_and_b32 v12, 7, v0
    v_xor_b32 v12, v12, v3
    v_xor_b32 v13, 4, v12
    v_lshl_add_u32 v12, v12, 4, v4
    v_lshl_add_u32 v13, v13, 4, v4
    v_add_u32 v14, 30720, v12
    v_add_u32 v15, 46080, v13
    v_add_u32 v13, 15360, v13
    s_mul_i32 s77, s48, 16384
    s_add_u32 s77, s77, 98304
    v_lshrrev_b32 v4, 1, v2
    v_xor_b32 v4, v4, v3
    v_lshlrev_b32 v4, 4, v4
    v_lshl_add_u32 v4, v2, 7, v4
    v_add_u32 v8, s77, v4
    v_xor_b32 v9, 64, v8
    s_lshl_b32 s52, s50, 11
    s_add_u32 s52, s52, 8388608
    v_lshl_add_u32 v23, v0, 3, s52
    s_lshl_b32 s53, s51, 2
    s_lshl_b64 s[56:57], 15, s53
    s_add_u32 s53, s53, s48
    s_lshl_b32 s53, s53, 3
    s_add_u32 s52, s52, s53
    v_mov_b32 v7, s52
    v_cmp_eq_u32 vcc, 0, v0
    v_bfrev_b32 v4, -2
    s_nop 0
    v_cndmask_b32 v7, v4, v7, vcc
    s_lshl_b32 s52, s49, 2
    s_add_u32 s52, s52, s48
    s_mul_i32 s52, s52, 229376
    v_mul_u32_u24 v4, 28672, v3
    v_add_u32 v4, s52, v4
    v_lshl_add_u32 v10, v2, 3, v4
    v_lshl_add_u32 v4, v2, 2, v4
    s_mul_i32 s52, s50, 256
    v_add_u32 v10, s52, v10
    s_mul_i32 s52, s50, 128
    s_add_u32 s52, s52, 4096
    v_add_u32 v11, s52, v4
    s_mul_i32 s52, s50, 64
    s_add_u32 s52, s52, 6144
    v_add_u32 v22, s52, v4
    s_branch L_pad1
.p2align 12
L_pad1:
    s_waitcnt vmcnt(12)
    v_lshlrev_b32 v1, 16, v1
    v_lshl_add_u32 v4, v0, 2, s10
    ds_write_b32 v4, v1
    s_waitcnt lgkmcnt(0)
    s_waitcnt vmcnt(11)
    v_and_b32 v27, 0xffff0000, v25
    v_lshlrev_b32 v26, 16, v25
    v_and_b32 v25, 0xffff0000, v24
    v_lshlrev_b32 v24, 16, v24
    s_waitcnt vmcnt(10)
    v_lshl_add_u32 v64, v64, 2, s10
    v_lshl_add_u32 v65, v65, 2, s10
    v_lshl_add_u32 v66, v66, 2, s10
    v_lshl_add_u32 v67, v67, 2, s10
    ds_read_b32 v32, v64
    ds_read_b32 v40, v65
    ds_read_b32 v48, v66
    ds_read_b32 v56, v67
    buffer_load_dwordx2 v[96:97], v20, s[24:27], 0 offen nt
    buffer_load_dword v112, v21, s[24:27], 0 offen nt
    s_waitcnt vmcnt(11)
    v_lshl_add_u32 v68, v68, 2, s10
    v_lshl_add_u32 v69, v69, 2, s10
    v_lshl_add_u32 v70, v70, 2, s10
    v_lshl_add_u32 v71, v71, 2, s10
    ds_read_b32 v33, v68
    ds_read_b32 v41, v69
    ds_read_b32 v49, v70
    ds_read_b32 v57, v71
    s_mov_b32 s52, 14336
    buffer_load_dwordx2 v[98:99], v20, s[24:27], s52 offen nt
    buffer_load_dword v113, v21, s[24:27], s52 offen nt
    s_waitcnt vmcnt(12)
    v_lshl_add_u32 v72, v72, 2, s10
    v_lshl_add_u32 v73, v73, 2, s10
    v_lshl_add_u32 v74, v74, 2, s10
    v_lshl_add_u32 v75, v75, 2, s10
    ds_read_b32 v34, v72
    ds_read_b32 v42, v73
    ds_read_b32 v50, v74
    ds_read_b32 v58, v75
    s_mov_b32 s52, 28672
    buffer_load_dwordx2 v[100:101], v20, s[24:27], s52 offen nt
    buffer_load_dword v114, v21, s[24:27], s52 offen nt
    s_waitcnt vmcnt(13)
    v_lshl_add_u32 v76, v76, 2, s10
    v_lshl_add_u32 v77, v77, 2, s10
    v_lshl_add_u32 v78, v78, 2, s10
    v_lshl_add_u32 v79, v79, 2, s10
    ds_read_b32 v35, v76
    ds_read_b32 v43, v77
    ds_read_b32 v51, v78
    ds_read_b32 v59, v79
    s_mov_b32 s52, 43008
    buffer_load_dwordx2 v[102:103], v20, s[24:27], s52 offen nt
    buffer_load_dword v115, v21, s[24:27], s52 offen nt
    s_waitcnt lgkmcnt(8)
    v_pk_mul_f32 v[32:33], v[32:33], v[24:25] op_sel_hi:[1,0]
    v_pk_mul_f32 v[40:41], v[40:41], v[24:25] op_sel:[0,1] op_sel_hi:[1,1]
    v_pk_mul_f32 v[48:49], v[48:49], v[26:27] op_sel_hi:[1,0]
    v_pk_mul_f32 v[56:57], v[56:57], v[26:27] op_sel:[0,1] op_sel_hi:[1,1]
    v_cvt_pk_bf16_f32 v32, v32, v33
    v_cvt_pk_bf16_f32 v40, v40, v41
    v_cvt_pk_bf16_f32 v48, v48, v49
    v_cvt_pk_bf16_f32 v56, v56, v57
    s_waitcnt vmcnt(14)
    v_lshl_add_u32 v80, v80, 2, s10
    v_lshl_add_u32 v81, v81, 2, s10
    v_lshl_add_u32 v82, v82, 2, s10
    v_lshl_add_u32 v83, v83, 2, s10
    ds_read_b32 v36, v80
    ds_read_b32 v44, v81
    ds_read_b32 v52, v82
    ds_read_b32 v60, v83
    s_mov_b32 s52, 57344
    buffer_load_dwordx2 v[104:105], v20, s[24:27], s52 offen nt
    buffer_load_dword v116, v21, s[24:27], s52 offen nt
    s_waitcnt vmcnt(15)
    v_lshl_add_u32 v84, v84, 2, s10
    v_lshl_add_u32 v85, v85, 2, s10
    v_lshl_add_u32 v86, v86, 2, s10
    v_lshl_add_u32 v87, v87, 2, s10
    ds_read_b32 v37, v84
    ds_read_b32 v45, v85
    ds_read_b32 v53, v86
    ds_read_b32 v61, v87
    s_mov_b32 s52, 71680
    buffer_load_dwordx2 v[106:107], v20, s[24:27], s52 offen nt
    buffer_load_dword v117, v21, s[24:27], s52 offen nt
    s_waitcnt lgkmcnt(8)
    v_pk_mul_f32 v[34:35], v[34:35], v[24:25] op_sel_hi:[1,0]
    v_pk_mul_f32 v[42:43], v[42:43], v[24:25] op_sel:[0,1] op_sel_hi:[1,1]
    v_pk_mul_f32 v[50:51], v[50:51], v[26:27] op_sel_hi:[1,0]
    v_pk_mul_f32 v[58:59], v[58:59], v[26:27] op_sel:[0,1] op_sel_hi:[1,1]
    v_cvt_pk_bf16_f32 v33, v34, v35
    v_cvt_pk_bf16_f32 v41, v42, v43
    v_cvt_pk_bf16_f32 v49, v50, v51
    v_cvt_pk_bf16_f32 v57, v58, v59
    s_waitcnt vmcnt(16)
    v_lshl_add_u32 v88, v88, 2, s10
    v_lshl_add_u32 v89, v89, 2, s10
    v_lshl_add_u32 v90, v90, 2, s10
    v_lshl_add_u32 v91, v91, 2, s10
    ds_read_b32 v38, v88
    ds_read_b32 v46, v89
    ds_read_b32 v54, v90
    ds_read_b32 v62, v91
    s_mov_b32 s52, 86016
    buffer_load_dwordx2 v[108:109], v20, s[24:27], s52 offen nt
    buffer_load_dword v118, v21, s[24:27], s52 offen nt
    s_waitcnt vmcnt(17)
    v_lshl_add_u32 v92, v92, 2, s10
    v_lshl_add_u32 v93, v93, 2, s10
    v_lshl_add_u32 v94, v94, 2, s10
    v_lshl_add_u32 v95, v95, 2, s10
    ds_read_b32 v39, v92
    ds_read_b32 v47, v93
    ds_read_b32 v55, v94
    ds_read_b32 v63, v95
    s_mov_b32 s52, 100352
    buffer_load_dwordx2 v[110:111], v20, s[24:27], s52 offen nt
    buffer_load_dword v119, v21, s[24:27], s52 offen nt
    s_waitcnt lgkmcnt(8)
    v_pk_mul_f32 v[36:37], v[36:37], v[24:25] op_sel_hi:[1,0]
    v_pk_mul_f32 v[44:45], v[44:45], v[24:25] op_sel:[0,1] op_sel_hi:[1,1]
    v_pk_mul_f32 v[52:53], v[52:53], v[26:27] op_sel_hi:[1,0]
    v_pk_mul_f32 v[60:61], v[60:61], v[26:27] op_sel:[0,1] op_sel_hi:[1,1]
    v_cvt_pk_bf16_f32 v34, v36, v37
    v_cvt_pk_bf16_f32 v42, v44, v45
    v_cvt_pk_bf16_f32 v50, v52, v53
    v_cvt_pk_bf16_f32 v58, v60, v61
    s_waitcnt lgkmcnt(0)
    v_pk_mul_f32 v[38:39], v[38:39], v[24:25] op_sel_hi:[1,0]
    v_pk_mul_f32 v[46:47], v[46:47], v[24:25] op_sel:[0,1] op_sel_hi:[1,1]
    v_pk_mul_f32 v[54:55], v[54:55], v[26:27] op_sel_hi:[1,0]
    v_pk_mul_f32 v[62:63], v[62:63], v[26:27] op_sel:[0,1] op_sel_hi:[1,1]
    v_cvt_pk_bf16_f32 v35, v38, v39
    v_cvt_pk_bf16_f32 v43, v46, v47
    v_cvt_pk_bf16_f32 v51, v54, v55
    v_cvt_pk_bf16_f32 v59, v62, v63
    s_lshl_b32 s79, s60, 2
    buffer_store_dwordx4 v[32:35], v16, s[40:43], s79 offen offset:0
    buffer_store_dwordx4 v[40:43], v16, s[40:43], s79 offen offset:1024
    buffer_store_dwordx4 v[48:51], v16, s[40:43], s79 offen offset:2048
    buffer_store_dwordx4 v[56:59], v16, s[40:43], s79 offen offset:3072
    buffer_load_dwordx2 v[248:249], off, s[44:47], 0 sc1
    s_add_u32 m0, s77, 0
    s_lshr_b32 s79, s60, 5
    buffer_load_dwordx4 v12, s[20:23], s79 offen offset:0  lds
    buffer_load_dwordx4 v13, s[20:23], s79 offen offset:1024  lds
    buffer_load_dwordx4 v14, s[20:23], s79 offen offset:2048  lds
    buffer_load_dwordx4 v15, s[20:23], s79 offen offset:3072  lds
    v_add_u32 v4, s4, v5
    ds_write_b128 v4, v[32:35] offset:0
    ds_write_b128 v4, v[40:43] offset:1024
    ds_write_b128 v4, v[48:51] offset:2048
    ds_write_b128 v4, v[56:59] offset:3072
    s_mov_b64 exec, 0
    s_cmp_eq_u32 s48, 0
    s_cbranch_scc1 L_pad2
    s_cmp_eq_u32 s48, 1
    s_cbranch_scc1 L_pad3
    s_cmp_eq_u32 s48, 2
    s_cbranch_scc1 L_pad4
    s_cmp_eq_u32 s48, 3
    s_cbranch_scc1 L_pad5
L_back:
    s_mov_b64 exec, -1
    s_waitcnt vmcnt(4)
    v_readfirstlane_b32 s54, v248
    v_readfirstlane_b32 s55, v249
    s_cmp_lg_u32 s54, 0
    s_cbranch_scc1 L_tagok
    s_mov_b32 s3, 131072
L_tagpoll:
    s_sub_u32 s3, s3, 1
    s_cbranch_scc1 L_tagok
    buffer_load_dwordx2 v[248:249], off, s[44:47], 0 sc1
    s_waitcnt vmcnt(0)
    v_readfirstlane_b32 s54, v248
    v_readfirstlane_b32 s55, v249
    s_cmp_lg_u32 s54, 0
    s_cbranch_scc0 L_tagpoll
L_tagok:
    s_mov_b32 s11, 0
    s_getreg_b32 s52, hwreg(HW_REG_XCC_ID, 0, 4)
    s_lshl4_add_u32 s55, s55, s52
    s_nop 0
    v_mov_b32 v2, s54
    v_mov_b32 v3, s55
    buffer_store_dwordx2 v[2:3], v7, s[40:43], 0 offen offset:0
    s_add_u32 m0, s77, 4096
    s_lshr_b32 s79, s61, 5
    buffer_load_dwordx4 v12, s[20:23], s79 offen offset:0  lds
    buffer_load_dwordx4 v13, s[20:23], s79 offen offset:1024  lds
    buffer_load_dwordx4 v14, s[20:23], s79 offen offset:2048  lds
    buffer_load_dwordx4 v15, s[20:23], s79 offen offset:3072  lds
    v_lshlrev_b32 v28, 16, v29
    v_and_b32 v29, 0xffff0000, v29
    v_lshlrev_b32 v30, 16, v30
    v_lshl_add_u32 v96, v96, 2, s10
    v_lshl_add_u32 v97, v97, 2, s10
    v_lshl_add_u32 v112, v112, 2, s10
    ds_read_b32 v64, v96
    ds_read_b32 v72, v97
    ds_read_b32 v80, v112
    v_lshl_add_u32 v98, v98, 2, s10
    v_lshl_add_u32 v99, v99, 2, s10
    v_lshl_add_u32 v113, v113, 2, s10
    ds_read_b32 v65, v98
    ds_read_b32 v73, v99
    ds_read_b32 v81, v113
    v_lshl_add_u32 v100, v100, 2, s10
    v_lshl_add_u32 v101, v101, 2, s10
    v_lshl_add_u32 v114, v114, 2, s10
    ds_read_b32 v66, v100
    ds_read_b32 v74, v101
    ds_read_b32 v82, v114
    v_lshl_add_u32 v102, v102, 2, s10
    v_lshl_add_u32 v103, v103, 2, s10
    v_lshl_add_u32 v115, v115, 2, s10
    ds_read_b32 v67, v102
    ds_read_b32 v75, v103
    ds_read_b32 v83, v115
    v_lshl_add_u32 v104, v104, 2, s10
    v_lshl_add_u32 v105, v105, 2, s10
    v_lshl_add_u32 v116, v116, 2, s10
    ds_read_b32 v68, v104
    ds_read_b32 v76, v105
    ds_read_b32 v84, v116
    v_lshl_add_u32 v106, v106, 2, s10
    v_lshl_add_u32 v107, v107, 2, s10
    v_lshl_add_u32 v117, v117, 2, s10
    ds_read_b32 v69, v106
    ds_read_b32 v77, v107
    ds_read_b32 v85, v117
    s_waitcnt lgkmcnt(12)
    v_pk_mul_f32 v[64:65], v[64:65], v[28:29] op_sel_hi:[1,0]
    v_pk_mul_f32 v[72:73], v[72:73], v[28:29] op_sel:[0,1] op_sel_hi:[1,1]
    v_pk_mul_f32 v[80:81], v[80:81], v[30:31] op_sel_hi:[1,0]
    v_cvt_pk_bf16_f32 v64, v64, v65
    v_cvt_pk_bf16_f32 v72, v72, v73
    v_cvt_pk_bf16_f32 v80, v80, v81
    v_lshl_add_u32 v108, v108, 2, s10
    v_lshl_add_u32 v109, v109, 2, s10
    v_lshl_add_u32 v118, v118, 2, s10
    ds_read_b32 v70, v108
    ds_read_b32 v78, v109
    ds_read_b32 v86, v118
    v_lshl_add_u32 v110, v110, 2, s10
    v_lshl_add_u32 v111, v111, 2, s10
    v_lshl_add_u32 v119, v119, 2, s10
    ds_read_b32 v71, v110
    ds_read_b32 v79, v111
    ds_read_b32 v87, v119
    s_waitcnt lgkmcnt(12)
    v_pk_mul_f32 v[66:67], v[66:67], v[28:29] op_sel_hi:[1,0]
    v_pk_mul_f32 v[74:75], v[74:75], v[28:29] op_sel:[0,1] op_sel_hi:[1,1]
    v_pk_mul_f32 v[82:83], v[82:83], v[30:31] op_sel_hi:[1,0]
    v_cvt_pk_bf16_f32 v65, v66, v67
    v_cvt_pk_bf16_f32 v73, v74, v75
    v_cvt_pk_bf16_f32 v81, v82, v83
    s_waitcnt lgkmcnt(6)
    v_pk_mul_f32 v[68:69], v[68:69], v[28:29] op_sel_hi:[1,0]
    v_pk_mul_f32 v[76:77], v[76:77], v[28:29] op_sel:[0,1] op_sel_hi:[1,1]
    v_pk_mul_f32 v[84:85], v[84:85], v[30:31] op_sel_hi:[1,0]
    v_cvt_pk_bf16_f32 v66, v68, v69
    v_cvt_pk_bf16_f32 v74, v76, v77
    v_cvt_pk_bf16_f32 v82, v84, v85
    s_waitcnt lgkmcnt(0)
    v_pk_mul_f32 v[70:71], v[70:71], v[28:29] op_sel_hi:[1,0]
    v_pk_mul_f32 v[78:79], v[78:79], v[28:29] op_sel:[0,1] op_sel_hi:[1,1]
    v_pk_mul_f32 v[86:87], v[86:87], v[30:31] op_sel_hi:[1,0]
    v_cvt_pk_bf16_f32 v67, v70, v71
    v_cvt_pk_bf16_f32 v75, v78, v79
    v_cvt_pk_bf16_f32 v83, v86, v87
    v_add_u32 v4, s5, v5
    ds_write_b128 v4, v[64:67] offset:16384
    ds_write_b128 v4, v[72:75] offset:17408
    v_add_u32 v4, s6, v5
    ds_write_b128 v4, v[80:83] offset:24576
    s_waitcnt vmcnt(5) lgkmcnt(0)
    s_barrier
    ds_read_b128 a[0:3], v8 offset:0
    ds_read_b128 a[4:7], v8 offset:2048
    ds_read_b128 a[8:11], v9 offset:0
    ds_read_b128 a[12:15], v9 offset:2048
    ds_read_b128 v[140:143], v5 offset:0
    ds_read_b128 v[136:139], v5 offset:1024
    ds_read_b128 v[132:135], v5 offset:2048
    ds_read_b128 v[128:131], v5 offset:3072
    ds_read_b128 v[124:127], v5 offset:4096
    s_waitcnt lgkmcnt(4)
    v_mfma_f32_16x16x32_bf16 v[144:147], a[0:3], v[140:143], 0
    v_mfma_f32_16x16x32_bf16 v[148:151], a[4:7], v[140:143], 0
    ds_read_b128 v[120:123], v5 offset:5120
    s_waitcnt lgkmcnt(4)
    v_mfma_f32_16x16x32_bf16 v[152:155], a[0:3], v[136:139], 0
    v_mfma_f32_16x16x32_bf16 v[156:159], a[4:7], v[136:139], 0
    ds_read_b128 v[140:143], v5 offset:6144
    s_waitcnt lgkmcnt(4)
    v_mfma_f32_16x16x32_bf16 v[160:163], a[0:3], v[132:135], 0
    v_mfma_f32_16x16x32_bf16 v[164:167], a[4:7], v[132:135], 0
    ds_read_b128 v[136:139], v5 offset:7168
    s_waitcnt lgkmcnt(4)
    v_mfma_f32_16x16x32_bf16 v[168:171], a[0:3], v[128:131], 0
    v_mfma_f32_16x16x32_bf16 v[172:175], a[4:7], v[128:131], 0
    ds_read_b128 v[132:135], v5 offset:8192
    s_waitcnt lgkmcnt(4)
    v_mfma_f32_16x16x32_bf16 v[176:179], a[0:3], v[124:127], 0
    v_mfma_f32_16x16x32_bf16 v[180:183], a[4:7], v[124:127], 0
    ds_read_b128 v[128:131], v5 offset:9216
    s_waitcnt lgkmcnt(4)
    v_mfma_f32_16x16x32_bf16 v[184:187], a[0:3], v[120:123], 0
    v_mfma_f32_16x16x32_bf16 v[188:191], a[4:7], v[120:123], 0
    ds_read_b128 v[124:127], v5 offset:10240
    s_waitcnt lgkmcnt(4)
    v_mfma_f32_16x16x32_bf16 v[192:195], a[0:3], v[140:143], 0
    v_mfma_f32_16x16x32_bf16 v[196:199], a[4:7], v[140:143], 0
    ds_read_b128 v[120:123], v5 offset:11264
    s_waitcnt lgkmcnt(4)
    v_mfma_f32_16x16x32_bf16 v[200:203], a[0:3], v[136:139], 0
    v_mfma_f32_16x16x32_bf16 v[204:207], a[4:7], v[136:139], 0
    ds_read_b128 v[140:143], v5 offset:12288
    s_waitcnt lgkmcnt(4)
    v_mfma_f32_16x16x32_bf16 v[144:147], a[8:11], v[132:135], v[144:147]
    v_mfma_f32_16x16x32_bf16 v[148:151], a[12:15], v[132:135], v[148:151]
    ds_read_b128 v[136:139], v5 offset:13312
    s_waitcnt lgkmcnt(4)
    v_mfma_f32_16x16x32_bf16 v[152:155], a[8:11], v[128:131], v[152:155]
    v_mfma_f32_16x16x32_bf16 v[156:159], a[12:15], v[128:131], v[156:159]
    ds_read_b128 v[132:135], v5 offset:14336
    s_waitcnt lgkmcnt(4)
    v_mfma_f32_16x16x32_bf16 v[160:163], a[8:11], v[124:127], v[160:163]
    v_mfma_f32_16x16x32_bf16 v[164:167], a[12:15], v[124:127], v[164:167]
    ds_read_b128 v[128:131], v5 offset:15360
    s_waitcnt lgkmcnt(4)
    v_mfma_f32_16x16x32_bf16 v[168:171], a[8:11], v[120:123], v[168:171]
    v_mfma_f32_16x16x32_bf16 v[172:175], a[12:15], v[120:123], v[172:175]
    s_waitcnt lgkmcnt(3)
    v_mfma_f32_16x16x32_bf16 v[176:179], a[8:11], v[140:143], v[176:179]
    v_mfma_f32_16x16x32_bf16 v[180:183], a[12:15], v[140:143], v[180:183]
    s_waitcnt lgkmcnt(2)
    v_mfma_f32_16x16x32_bf16 v[184:187], a[8:11], v[136:139], v[184:187]
    v_mfma_f32_16x16x32_bf16 v[188:191], a[12:15], v[136:139], v[188:191]
    s_waitcnt lgkmcnt(1)
    v_mfma_f32_16x16x32_bf16 v[192:195], a[8:11], v[132:135], v[192:195]
    v_mfma_f32_16x16x32_bf16 v[196:199], a[12:15], v[132:135], v[196:199]
    s_waitcnt lgkmcnt(0)
    v_mfma_f32_16x16x32_bf16 v[200:203], a[8:11], v[128:131], v[200:203]
    v_mfma_f32_16x16x32_bf16 v[204:207], a[12:15], v[128:131], v[204:207]
    buffer_load_dwordx2 v[62:63], v23, s[40:43], 0 offen offset:0 sc1
    s_add_u32 m0, s77, 8192
    s_lshr_b32 s79, s62, 5
    buffer_load_dwordx4 v12, s[20:23], s79 offen offset:0  lds
    buffer_load_dwordx4 v13, s[20:23], s79 offen offset:1024  lds
    buffer_load_dwordx4 v14, s[20:23], s79 offen offset:2048  lds
    buffer_load_dwordx4 v15, s[20:23], s79 offen offset:3072  lds
    s_waitcnt vmcnt(4)
    v_cmp_eq_u64 vcc, s[54:55], v[62:63]
    s_or_b64 s[58:59], vcc, s[56:57]
    s_cmp_eq_u64 s[58:59], -1
    s_cbranch_scc1 L_ok_l
    s_mov_b32 s3, 32
L_poll_l:
    buffer_load_dwordx2 v[62:63], v23, s[40:43], 0 offen offset:0 sc1
    s_waitcnt vmcnt(0)
    v_cmp_eq_u64 vcc, s[54:55], v[62:63]
    s_or_b64 s[58:59], vcc, s[56:57]
    s_cmp_eq_u64 s[58:59], -1
    s_cbranch_scc1 L_ok_l
    s_sub_u32 s3, s3, 1
    s_cbranch_scc0 L_poll_l
    s_branch L_slow
L_ok_l:
    s_and_b32 s55, s55, -16
    v_mov_b32 v3, s55
    s_add_u32 m0, s4, 28672
    s_lshl_b32 s79, s61, 2
    buffer_load_dwordx4 v16, s[40:43], s79 offen offset:0 sc1 lds
    buffer_load_dwordx4 v16, s[40:43], s79 offen offset:1024 sc1 lds
    buffer_load_dwordx4 v16, s[40:43], s79 offen offset:2048 sc1 lds
    buffer_load_dwordx4 v16, s[40:43], s79 offen offset:3072 sc1 lds
    s_add_u32 m0, s4, 45056
    s_lshl_b32 s79, s62, 2
    buffer_load_dwordx4 v16, s[40:43], s79 offen offset:0 sc1 lds
    buffer_load_dwordx4 v16, s[40:43], s79 offen offset:1024 sc1 lds
    buffer_load_dwordx4 v16, s[40:43], s79 offen offset:2048 sc1 lds
    buffer_load_dwordx4 v16, s[40:43], s79 offen offset:3072 sc1 lds
    s_cmp_lg_u32 s11, 0
    s_cbranch_scc1 L_far_stb
    s_lshl_b32 s79, s60, 1
    buffer_store_dwordx4 v[64:67], v17, s[40:43], s79 offen offset:0
    buffer_store_dwordx4 v[72:75], v17, s[40:43], s79 offen offset:1024
    buffer_store_dwordx4 v[80:83], v18, s[40:43], s60 offen offset:0
L_near_stb:
    s_add_u32 m0, s77, 12288
    s_lshr_b32 s79, s63, 5
    buffer_load_dwordx4 v12, s[20:23], s79 offen offset:0  lds
    buffer_load_dwordx4 v13, s[20:23], s79 offen offset:1024  lds
    buffer_load_dwordx4 v14, s[20:23], s79 offen offset:2048  lds
    buffer_load_dwordx4 v15, s[20:23], s79 offen offset:3072  lds
    s_barrier
    ds_read_b128 a[16:19], v8 offset:4096
    ds_read_b128 a[20:23], v8 offset:6144
    ds_read_b128 a[24:27], v9 offset:4096
    ds_read_b128 a[28:31], v9 offset:6144
    v_add_u32 v19, 0x20000, v5
L_fork:
    s_waitcnt vmcnt(11)
    s_barrier
    ds_read_b128 v[140:143], v5 offset:28672
    ds_read_b128 v[136:139], v5 offset:29696
    ds_read_b128 v[132:135], v5 offset:30720
    ds_read_b128 v[128:131], v5 offset:31744
    ds_read_b128 v[124:127], v5 offset:32768
    ds_read_b128 v[120:123], v5 offset:33792
    s_waitcnt lgkmcnt(5)
    v_mfma_f32_16x16x32_bf16 v[144:147], a[16:19], v[140:143], v[144:147]
    v_mfma_f32_16x16x32_bf16 v[148:151], a[20:23], v[140:143], v[148:151]
    ds_read_b128 v[116:119], v5 offset:34816
    s_waitcnt lgkmcnt(4)
    v_mfma_f32_16x16x32_bf16 v[152:155], a[16:19], v[136:139], v[152:155]
    s_add_u32 m0, s4, 61440
    s_lshl_b32 s79, s63, 2
    v_mfma_f32_16x16x32_bf16 v[156:159], a[20:23], v[136:139], v[156:159]
    ds_read_b128 v[112:115], v5 offset:35840
    v_mfma_f32_16x16x32_bf16 v[160:163], a[16:19], v[132:135], v[160:163]
    buffer_load_dwordx4 v16, s[40:43], s79 offen offset:0 sc1 lds
    v_mfma_f32_16x16x32_bf16 v[164:167], a[20:23], v[132:135], v[164:167]
    ds_read_b128 v[140:143], v5 offset:36864
    s_waitcnt lgkmcnt(4)
    v_mfma_f32_16x16x32_bf16 v[168:171], a[16:19], v[128:131], v[168:171]
    buffer_load_dwordx4 v16, s[40:43], s79 offen offset:1024 sc1 lds
    v_mfma_f32_16x16x32_bf16 v[172:175], a[20:23], v[128:131], v[172:175]
    ds_read_b128 v[136:139], v5 offset:37888
    v_mfma_f32_16x16x32_bf16 v[176:179], a[16:19], v[124:127], v[176:179]
    buffer_load_dwordx4 v16, s[40:43], s79 offen offset:2048 sc1 lds
    v_mfma_f32_16x16x32_bf16 v[180:183], a[20:23], v[124:127], v[180:183]
    ds_read_b128 v[132:135], v5 offset:38912
    s_waitcnt lgkmcnt(4)
    v_mfma_f32_16x16x32_bf16 v[184:187], a[16:19], v[120:123], v[184:187]
    buffer_load_dwordx4 v16, s[40:43], s79 offen offset:3072 sc1 lds
    v_mfma_f32_16x16x32_bf16 v[188:191], a[20:23], v[120:123], v[188:191]
    ds_read_b128 v[128:131], v5 offset:39936
    s_waitcnt vmcnt(8)
    v_mfma_f32_16x16x32_bf16 v[192:195], a[16:19], v[116:119], v[192:195]
    s_cmp_lg_u32 s11, 0
    s_cbranch_scc1 L_far_flb
    buffer_store_dwordx2 v[2:3], v7, s[40:43], 0 offen offset:1024
L_near_flb:
    v_mfma_f32_16x16x32_bf16 v[196:199], a[20:23], v[116:119], v[196:199]
    ds_read_b128 v[124:127], v5 offset:40960
    s_waitcnt lgkmcnt(4)
    v_mfma_f32_16x16x32_bf16 v[200:203], a[16:19], v[112:115], v[200:203]
    s_add_u32 m0, s77, 0
    s_lshr_b32 s79, s64, 5
    v_mfma_f32_16x16x32_bf16 v[204:207], a[20:23], v[112:115], v[204:207]
    ds_read_b128 v[120:123], v5 offset:41984
    v_mfma_f32_16x16x32_bf16 v[144:147], a[24:27], v[140:143], v[144:147]
    buffer_load_dwordx4 v12, s[20:23], s79 offen offset:0  lds
    v_mfma_f32_16x16x32_bf16 v[148:151], a[28:31], v[140:143], v[148:151]
    ds_read_b128 v[116:119], v5 offset:43008
    s_waitcnt lgkmcnt(4)
    v_mfma_f32_16x16x32_bf16 v[152:155], a[24:27], v[136:139], v[152:155]
    buffer_load_dwordx4 v13, s[20:23], s79 offen offset:1024  lds
    v_mfma_f32_16x16x32_bf16 v[156:159], a[28:31], v[136:139], v[156:159]
    ds_read_b128 v[112:115], v5 offset:44032
    v_mfma_f32_16x16x32_bf16 v[160:163], a[24:27], v[132:135], v[160:163]
    buffer_load_dwordx4 v14, s[20:23], s79 offen offset:2048  lds
    v_mfma_f32_16x16x32_bf16 v[164:167], a[28:31], v[132:135], v[164:167]
    s_barrier
    ds_read_b128 v[140:143], v5 offset:16384
    s_waitcnt lgkmcnt(4)
    v_mfma_f32_16x16x32_bf16 v[168:171], a[24:27], v[128:131], v[168:171]
    buffer_load_dwordx4 v15, s[20:23], s79 offen offset:3072  lds
    v_mfma_f32_16x16x32_bf16 v[172:175], a[28:31], v[128:131], v[172:175]
    ds_read_b128 v[136:139], v5 offset:17408
    v_mfma_f32_16x16x32_bf16 v[176:179], a[24:27], v[124:127], v[176:179]
    v_mfma_f32_16x16x32_bf16 v[180:183], a[28:31], v[124:127], v[180:183]
    ds_read_b128 v[132:135], v5 offset:18432
    s_waitcnt lgkmcnt(4)
    v_mfma_f32_16x16x32_bf16 v[184:187], a[24:27], v[120:123], v[184:187]
    v_mfma_f32_16x16x32_bf16 v[188:191], a[28:31], v[120:123], v[188:191]
    ds_read_b128 v[128:131], v5 offset:19456
    v_mfma_f32_16x16x32_bf16 v[192:195], a[24:27], v[116:119], v[192:195]
    v_mfma_f32_16x16x32_bf16 v[196:199], a[28:31], v[116:119], v[196:199]
    ds_read_b128 v[124:127], v5 offset:20480
    s_waitcnt lgkmcnt(4)
    v_mfma_f32_16x16x32_bf16 v[200:203], a[24:27], v[112:115], v[200:203]
    v_mfma_f32_16x16x32_bf16 v[204:207], a[28:31], v[112:115], v[204:207]
    ds_read_b128 v[120:123], v5 offset:21504
    s_add_u32 m0, s4, 77824
    v_mfma_f32_16x16x32_bf16 v[208:211], a[0:3], v[140:143], 0
    s_lshl_b32 s79, s64, 2
    v_mfma_f32_16x16x32_bf16 v[212:215], a[4:7], v[140:143], 0
    ds_read_b128 v[116:119], v5 offset:22528
    s_waitcnt lgkmcnt(4)
    v_mfma_f32_16x16x32_bf16 v[216:219], a[0:3], v[136:139], 0
    buffer_load_dwordx4 v16, s[40:43], s79 offen offset:0 sc1 lds
    v_mfma_f32_16x16x32_bf16 v[220:223], a[4:7], v[136:139], 0
    ds_read_b128 v[112:115], v5 offset:23552
    v_mfma_f32_16x16x32_bf16 v[224:227], a[0:3], v[132:135], 0
    buffer_load_dwordx4 v16, s[40:43], s79 offen offset:1024 sc1 lds
    v_mfma_f32_16x16x32_bf16 v[228:231], a[4:7], v[132:135], 0
    ds_read_b128 v[140:143], v5 offset:24576
    s_waitcnt lgkmcnt(4)
    v_mfma_f32_16x16x32_bf16 v[232:235], a[0:3], v[128:131], 0
    buffer_load_dwordx4 v16, s[40:43], s79 offen offset:2048 sc1 lds
    v_mfma_f32_16x16x32_bf16 v[236:239], a[4:7], v[128:131], 0
    ds_read_b128 v[136:139], v5 offset:25600
    v_mfma_f32_16x16x32_bf16 v[208:211], a[8:11], v[124:127], v[208:211]
    buffer_load_dwordx4 v16, s[40:43], s79 offen offset:3072 sc1 lds
    v_mfma_f32_16x16x32_bf16 v[212:215], a[12:15], v[124:127], v[212:215]
    ds_read_b128 v[132:135], v5 offset:26624
    s_waitcnt lgkmcnt(4)
    v_mfma_f32_16x16x32_bf16 v[216:219], a[8:11], v[120:123], v[216:219]
    ds_read_b128 a[32:35], v8 offset:8192
    v_mfma_f32_16x16x32_bf16 v[220:223], a[12:15], v[120:123], v[220:223]
    ds_read_b128 v[128:131], v5 offset:27648
    ds_read_b128 a[36:39], v8 offset:10240
    v_mfma_f32_16x16x32_bf16 v[224:227], a[8:11], v[116:119], v[224:227]
    ds_read_b128 a[40:43], v9 offset:8192
    ds_read_b128 a[44:47], v9 offset:10240
    v_mfma_f32_16x16x32_bf16 v[228:231], a[12:15], v[116:119], v[228:231]
    ds_read_b128 v[124:127], v5 offset:45056
    s_waitcnt lgkmcnt(8)
    v_mfma_f32_16x16x32_bf16 v[232:235], a[8:11], v[112:115], v[232:235]
    v_mfma_f32_16x16x32_bf16 v[236:239], a[12:15], v[112:115], v[236:239]
    ds_read_b128 v[120:123], v5 offset:46080
    v_mfma_f32_16x16x32_bf16 v[240:243], a[0:3], v[140:143], 0
    v_mfma_f32_16x16x32_bf16 v[244:247], a[4:7], v[140:143], 0
    ds_read_b128 v[116:119], v5 offset:47104
    s_waitcnt lgkmcnt(8)
    v_mfma_f32_16x16x32_bf16 v[248:251], a[0:3], v[136:139], 0
    buffer_load_dwordx2 v[62:63], v23, s[40:43], 0 offen offset:1024 sc1
    v_mfma_f32_16x16x32_bf16 v[252:255], a[4:7], v[136:139], 0
    ds_read_b128 v[112:115], v5 offset:48128
    v_mfma_f32_16x16x32_bf16 v[240:243], a[8:11], v[132:135], v[240:243]
    v_mfma_f32_16x16x32_bf16 v[244:247], a[12:15], v[132:135], v[244:247]
    ds_read_b128 v[140:143], v5 offset:49152
    s_waitcnt lgkmcnt(4)
    v_mfma_f32_16x16x32_bf16 v[248:251], a[8:11], v[128:131], v[248:251]
    v_mfma_f32_16x16x32_bf16 v[252:255], a[12:15], v[128:131], v[252:255]
    ds_read_b128 v[136:139], v5 offset:50176
    v_mfma_f32_16x16x32_bf16 v[144:147], a[32:35], v[124:127], v[144:147]
    v_mfma_f32_16x16x32_bf16 v[148:151], a[36:39], v[124:127], v[148:151]
    ds_read_b128 v[132:135], v5 offset:51200
    s_waitcnt lgkmcnt(4)
    v_mfma_f32_16x16x32_bf16 v[152:155], a[32:35], v[120:123], v[152:155]
    s_add_u32 m0, s77, 4096
    s_lshr_b32 s79, s65, 5
    v_mfma_f32_16x16x32_bf16 v[156:159], a[36:39], v[120:123], v[156:159]
    ds_read_b128 v[128:131], v5 offset:52224
    v_mfma_f32_16x16x32_bf16 v[160:163], a[32:35], v[116:119], v[160:163]
    buffer_load_dwordx4 v12, s[20:23], s79 offen offset:0  lds
    v_mfma_f32_16x16x32_bf16 v[164:167], a[36:39], v[116:119], v[164:167]
    ds_read_b128 v[124:127], v5 offset:53248
    s_waitcnt lgkmcnt(4)
    v_mfma_f32_16x16x32_bf16 v[168:171], a[32:35], v[112:115], v[168:171]
    v_mfma_f32_16x16x32_bf16 v[172:175], a[36:39], v[112:115], v[172:175]
    ds_read_b128 v[120:123], v5 offset:54272
    v_mfma_f32_16x16x32_bf16 v[176:179], a[32:35], v[140:143], v[176:179]
    buffer_load_dwordx4 v13, s[20:23], s79 offen offset:1024  lds
    v_mfma_f32_16x16x32_bf16 v[180:183], a[36:39], v[140:143], v[180:183]
    ds_read_b128 v[116:119], v5 offset:55296
    s_waitcnt lgkmcnt(4)
    v_mfma_f32_16x16x32_bf16 v[184:187], a[32:35], v[136:139], v[184:187]
    v_mfma_f32_16x16x32_bf16 v[188:191], a[36:39], v[136:139], v[188:191]
    ds_read_b128 v[112:115], v5 offset:56320
    v_mfma_f32_16x16x32_bf16 v[192:195], a[32:35], v[132:135], v[192:195]
    buffer_load_dwordx4 v14, s[20:23], s79 offen offset:2048  lds
    v_mfma_f32_16x16x32_bf16 v[196:199], a[36:39], v[132:135], v[196:199]
    ds_read_b128 v[140:143], v5 offset:57344
    s_waitcnt lgkmcnt(4)
    v_mfma_f32_16x16x32_bf16 v[200:203], a[32:35], v[128:131], v[200:203]
    v_mfma_f32_16x16x32_bf16 v[204:207], a[36:39], v[128:131], v[204:207]
    ds_read_b128 v[136:139], v5 offset:58368
    v_mfma_f32_16x16x32_bf16 v[144:147], a[40:43], v[124:127], v[144:147]
    buffer_load_dwordx4 v15, s[20:23], s79 offen offset:3072  lds
    v_mfma_f32_16x16x32_bf16 v[148:151], a[44:47], v[124:127], v[148:151]
    ds_read_b128 v[132:135], v5 offset:59392
    s_waitcnt lgkmcnt(4)
    v_mfma_f32_16x16x32_bf16 v[152:155], a[40:43], v[120:123], v[152:155]
    s_waitcnt vmcnt(18)
    ds_read_b128 a[48:51], v8 offset:12288
L_pad2:
    s_cbranch_execz L_back
    v_mfma_f32_16x16x32_bf16 v[156:159], a[44:47], v[120:123], v[156:159]
    ds_read_b128 v[128:131], v5 offset:60416
    ds_read_b128 a[52:55], v8 offset:14336
    v_mfma_f32_16x16x32_bf16 v[160:163], a[40:43], v[116:119], v[160:163]
    ds_read_b128 a[56:59], v9 offset:12288
    ds_read_b128 a[60:63], v9 offset:14336
    v_mfma_f32_16x16x32_bf16 v[164:167], a[44:47], v[116:119], v[164:167]
    s_waitcnt vmcnt(14)
    s_barrier
    ds_read_b128 v[124:127], v5 offset:61440
    s_waitcnt lgkmcnt(8)
    v_mfma_f32_16x16x32_bf16 v[168:171], a[40:43], v[112:115], v[168:171]
    s_waitcnt vmcnt(4)
    v_cmp_eq_u64 vcc, s[54:55], v[62:63]
    s_or_b64 s[58:59], vcc, s[56:57]
    s_cmp_eq_u64 s[58:59], -1
    s_cbranch_scc1 L_ok_b
    s_mov_b32 s3, 131072
L_poll_b:
    s_sub_u32 s3, s3, 1
    s_cbranch_scc1 L_ok_b
    buffer_load_dwordx2 v[62:63], v23, s[40:43], 0 offen offset:1024 sc1
    s_waitcnt vmcnt(0)
    v_cmp_eq_u64 vcc, s[54:55], v[62:63]
    s_or_b64 s[58:59], vcc, s[56:57]
    s_cmp_eq_u64 s[58:59], -1
    s_cbranch_scc0 L_poll_b
L_ok_b:
    s_add_u32 m0, s5, 0
    s_lshl_b32 s79, s61, 1
    v_mfma_f32_16x16x32_bf16 v[172:175], a[44:47], v[112:115], v[172:175]
    ds_read_b128 v[120:123], v5 offset:62464
    v_mfma_f32_16x16x32_bf16 v[176:179], a[40:43], v[140:143], v[176:179]
    buffer_load_dwordx4 v17, s[40:43], s79 offen offset:0 sc1 lds
    v_mfma_f32_16x16x32_bf16 v[180:183], a[44:47], v[140:143], v[180:183]
    ds_read_b128 v[116:119], v5 offset:63488
    s_waitcnt lgkmcnt(8)
    v_mfma_f32_16x16x32_bf16 v[184:187], a[40:43], v[136:139], v[184:187]
    v_mfma_f32_16x16x32_bf16 v[188:191], a[44:47], v[136:139], v[188:191]
    ds_read_b128 v[112:115], v5 offset:64512
    v_mfma_f32_16x16x32_bf16 v[192:195], a[40:43], v[132:135], v[192:195]
    buffer_load_dwordx4 v17, s[40:43], s79 offen offset:1024 sc1 lds
    v_mfma_f32_16x16x32_bf16 v[196:199], a[44:47], v[132:135], v[196:199]
    ds_read_b128 v[140:143], v6 offset:0
    s_waitcnt lgkmcnt(4)
    v_mfma_f32_16x16x32_bf16 v[200:203], a[40:43], v[128:131], v[200:203]
    s_add_u32 m0, s4, 8192
    s_lshl_b32 s79, s65, 2
    v_mfma_f32_16x16x32_bf16 v[204:207], a[44:47], v[128:131], v[204:207]
    ds_read_b128 v[136:139], v6 offset:1024
    v_mfma_f32_16x16x32_bf16 v[144:147], a[48:51], v[124:127], v[144:147]
    buffer_load_dwordx4 v16, s[40:43], s79 offen offset:0 sc1 lds
    v_mfma_f32_16x16x32_bf16 v[148:151], a[52:55], v[124:127], v[148:151]
    ds_read_b128 v[132:135], v6 offset:2048
    s_waitcnt lgkmcnt(4)
    v_mfma_f32_16x16x32_bf16 v[152:155], a[48:51], v[120:123], v[152:155]
    v_mfma_f32_16x16x32_bf16 v[156:159], a[52:55], v[120:123], v[156:159]
    ds_read_b128 v[128:131], v6 offset:3072
    v_mfma_f32_16x16x32_bf16 v[160:163], a[48:51], v[116:119], v[160:163]
    buffer_load_dwordx4 v16, s[40:43], s79 offen offset:1024 sc1 lds
    v_mfma_f32_16x16x32_bf16 v[164:167], a[52:55], v[116:119], v[164:167]
    ds_read_b128 v[124:127], v6 offset:4096
    s_waitcnt lgkmcnt(4)
    v_mfma_f32_16x16x32_bf16 v[168:171], a[48:51], v[112:115], v[168:171]
    v_mfma_f32_16x16x32_bf16 v[172:175], a[52:55], v[112:115], v[172:175]
    ds_read_b128 v[120:123], v6 offset:5120
    v_mfma_f32_16x16x32_bf16 v[176:179], a[48:51], v[140:143], v[176:179]
    buffer_load_dwordx4 v16, s[40:43], s79 offen offset:2048 sc1 lds
    v_mfma_f32_16x16x32_bf16 v[180:183], a[52:55], v[140:143], v[180:183]
    ds_read_b128 v[116:119], v6 offset:6144
    s_waitcnt lgkmcnt(4)
    v_mfma_f32_16x16x32_bf16 v[184:187], a[48:51], v[136:139], v[184:187]
    v_mfma_f32_16x16x32_bf16 v[188:191], a[52:55], v[136:139], v[188:191]
    ds_read_b128 v[112:115], v6 offset:7168
    v_mfma_f32_16x16x32_bf16 v[192:195], a[48:51], v[132:135], v[192:195]
    buffer_load_dwordx4 v16, s[40:43], s79 offen offset:3072 sc1 lds
    v_mfma_f32_16x16x32_bf16 v[196:199], a[52:55], v[132:135], v[196:199]
    ds_read_b128 v[140:143], v6 offset:8192
    s_waitcnt lgkmcnt(4)
    v_mfma_f32_16x16x32_bf16 v[200:203], a[48:51], v[128:131], v[200:203]
    ds_read_b128 a[64:67], v8 offset:0
    v_mfma_f32_16x16x32_bf16 v[204:207], a[52:55], v[128:131], v[204:207]
    ds_read_b128 v[136:139], v6 offset:9216
    ds_read_b128 a[68:71], v8 offset:2048
    v_mfma_f32_16x16x32_bf16 v[144:147], a[56:59], v[124:127], v[144:147]
    ds_read_b128 a[72:75], v9 offset:0
    ds_read_b128 a[76:79], v9 offset:2048
    v_mfma_f32_16x16x32_bf16 v[148:151], a[60:63], v[124:127], v[148:151]
    ds_read_b128 v[132:135], v6 offset:10240
    s_waitcnt lgkmcnt(8)
    v_mfma_f32_16x16x32_bf16 v[152:155], a[56:59], v[120:123], v[152:155]
    s_add_u32 m0, s77, 8192
    s_lshr_b32 s79, s66, 5
    v_mfma_f32_16x16x32_bf16 v[156:159], a[60:63], v[120:123], v[156:159]
    ds_read_b128 v[128:131], v6 offset:11264
    v_mfma_f32_16x16x32_bf16 v[160:163], a[56:59], v[116:119], v[160:163]
    buffer_load_dwordx4 v12, s[20:23], s79 offen offset:0  lds
    v_mfma_f32_16x16x32_bf16 v[164:167], a[60:63], v[116:119], v[164:167]
    s_barrier
    ds_read_b128 v[124:127], v6 offset:12288
    s_waitcnt lgkmcnt(8)
    v_mfma_f32_16x16x32_bf16 v[168:171], a[56:59], v[112:115], v[168:171]
    v_mfma_f32_16x16x32_bf16 v[172:175], a[60:63], v[112:115], v[172:175]
    ds_read_b128 v[120:123], v6 offset:13312
    v_mfma_f32_16x16x32_bf16 v[176:179], a[56:59], v[140:143], v[176:179]
    buffer_load_dwordx4 v13, s[20:23], s79 offen offset:1024  lds
    v_mfma_f32_16x16x32_bf16 v[180:183], a[60:63], v[140:143], v[180:183]
    ds_read_b128 v[116:119], v6 offset:14336
    s_waitcnt lgkmcnt(4)
    v_mfma_f32_16x16x32_bf16 v[184:187], a[56:59], v[136:139], v[184:187]
    v_mfma_f32_16x16x32_bf16 v[188:191], a[60:63], v[136:139], v[188:191]
    ds_read_b128 v[112:115], v6 offset:15360
    v_mfma_f32_16x16x32_bf16 v[192:195], a[56:59], v[132:135], v[192:195]
    buffer_load_dwordx4 v14, s[20:23], s79 offen offset:2048  lds
    v_mfma_f32_16x16x32_bf16 v[196:199], a[60:63], v[132:135], v[196:199]
    ds_read_b128 v[140:143], v6 offset:16384
    s_waitcnt lgkmcnt(4)
    v_mfma_f32_16x16x32_bf16 v[200:203], a[56:59], v[128:131], v[200:203]
    v_mfma_f32_16x16x32_bf16 v[204:207], a[60:63], v[128:131], v[204:207]
    ds_read_b128 v[136:139], v6 offset:17408
    v_mfma_f32_16x16x32_bf16 v[144:147], a[64:67], v[124:127], v[144:147]
    buffer_load_dwordx4 v15, s[20:23], s79 offen offset:3072  lds
    v_mfma_f32_16x16x32_bf16 v[148:151], a[68:71], v[124:127], v[148:151]
    ds_read_b128 v[132:135], v6 offset:18432
    s_waitcnt lgkmcnt(4)
    v_mfma_f32_16x16x32_bf16 v[152:155], a[64:67], v[120:123], v[152:155]
    s_add_u32 m0, s5, 24576
    s_lshl_b32 s79, s62, 1
    v_mfma_f32_16x16x32_bf16 v[156:159], a[68:71], v[120:123], v[156:159]
    ds_read_b128 v[128:131], v6 offset:19456
    v_mfma_f32_16x16x32_bf16 v[160:163], a[64:67], v[116:119], v[160:163]
    buffer_load_dwordx4 v17, s[40:43], s79 offen offset:0 sc1 lds
    v_mfma_f32_16x16x32_bf16 v[164:167], a[68:71], v[116:119], v[164:167]
    ds_read_b128 v[124:127], v6 offset:20480
    s_waitcnt lgkmcnt(4)
    v_mfma_f32_16x16x32_bf16 v[168:171], a[64:67], v[112:115], v[168:171]
    v_mfma_f32_16x16x32_bf16 v[172:175], a[68:71], v[112:115], v[172:175]
    ds_read_b128 v[120:123], v6 offset:21504
    v_mfma_f32_16x16x32_bf16 v[176:179], a[64:67], v[140:143], v[176:179]
    buffer_load_dwordx4 v17, s[40:43], s79 offen offset:1024 sc1 lds
    v_mfma_f32_16x16x32_bf16 v[180:183], a[68:71], v[140:143], v[180:183]
    ds_read_b128 v[116:119], v6 offset:22528
    s_waitcnt lgkmcnt(4)
    v_mfma_f32_16x16x32_bf16 v[184:187], a[64:67], v[136:139], v[184:187]
    s_add_u32 m0, s4, 32768
    s_lshl_b32 s79, s66, 2
    v_mfma_f32_16x16x32_bf16 v[188:191], a[68:71], v[136:139], v[188:191]
    ds_read_b128 v[112:115], v6 offset:23552
    v_mfma_f32_16x16x32_bf16 v[192:195], a[64:67], v[132:135], v[192:195]
    buffer_load_dwordx4 v16, s[40:43], s79 offen offset:0 sc1 lds
    v_mfma_f32_16x16x32_bf16 v[196:199], a[68:71], v[132:135], v[196:199]
    ds_read_b128 v[140:143], v6 offset:24576
    s_waitcnt lgkmcnt(4)
    v_mfma_f32_16x16x32_bf16 v[200:203], a[64:67], v[128:131], v[200:203]
    v_mfma_f32_16x16x32_bf16 v[204:207], a[68:71], v[128:131], v[204:207]
    ds_read_b128 v[136:139], v6 offset:25600
    v_mfma_f32_16x16x32_bf16 v[144:147], a[72:75], v[124:127], v[144:147]
    buffer_load_dwordx4 v16, s[40:43], s79 offen offset:1024 sc1 lds
    v_mfma_f32_16x16x32_bf16 v[148:151], a[76:79], v[124:127], v[148:151]
    ds_read_b128 v[132:135], v6 offset:26624
    s_waitcnt lgkmcnt(4)
    v_mfma_f32_16x16x32_bf16 v[152:155], a[72:75], v[120:123], v[152:155]
    v_mfma_f32_16x16x32_bf16 v[156:159], a[76:79], v[120:123], v[156:159]
    ds_read_b128 v[128:131], v6 offset:27648
    v_mfma_f32_16x16x32_bf16 v[160:163], a[72:75], v[116:119], v[160:163]
    buffer_load_dwordx4 v16, s[40:43], s79 offen offset:2048 sc1 lds
    v_mfma_f32_16x16x32_bf16 v[164:167], a[76:79], v[116:119], v[164:167]
    s_waitcnt vmcnt(9)
    s_barrier
    ds_read_b128 v[124:127], v5 offset:0
    s_waitcnt lgkmcnt(4)
    v_mfma_f32_16x16x32_bf16 v[168:171], a[72:75], v[112:115], v[168:171]
    v_mfma_f32_16x16x32_bf16 v[172:175], a[76:79], v[112:115], v[172:175]
    ds_read_b128 v[120:123], v5 offset:1024
    v_mfma_f32_16x16x32_bf16 v[176:179], a[72:75], v[140:143], v[176:179]
    buffer_load_dwordx4 v16, s[40:43], s79 offen offset:3072 sc1 lds
    v_mfma_f32_16x16x32_bf16 v[180:183], a[76:79], v[140:143], v[180:183]
    ds_read_b128 v[116:119], v5 offset:2048
    s_waitcnt lgkmcnt(4)
    v_mfma_f32_16x16x32_bf16 v[184:187], a[72:75], v[136:139], v[184:187]
    ds_read_b128 a[80:83], v8 offset:4096
    v_mfma_f32_16x16x32_bf16 v[188:191], a[76:79], v[136:139], v[188:191]
    ds_read_b128 v[112:115], v5 offset:3072
    ds_read_b128 a[84:87], v8 offset:6144
    v_mfma_f32_16x16x32_bf16 v[192:195], a[72:75], v[132:135], v[192:195]
    ds_read_b128 a[88:91], v9 offset:4096
    ds_read_b128 a[92:95], v9 offset:6144
    v_mfma_f32_16x16x32_bf16 v[196:199], a[76:79], v[132:135], v[196:199]
    ds_read_b128 v[140:143], v5 offset:4096
    s_waitcnt lgkmcnt(8)
    v_mfma_f32_16x16x32_bf16 v[200:203], a[72:75], v[128:131], v[200:203]
    v_mfma_f32_16x16x32_bf16 v[204:207], a[76:79], v[128:131], v[204:207]
    ds_read_b128 v[136:139], v5 offset:5120
    v_mfma_f32_16x16x32_bf16 v[208:211], a[16:19], v[124:127], v[208:211]
    v_mfma_f32_16x16x32_bf16 v[212:215], a[20:23], v[124:127], v[212:215]
    ds_read_b128 v[132:135], v5 offset:6144
    s_waitcnt lgkmcnt(8)
    v_mfma_f32_16x16x32_bf16 v[216:219], a[16:19], v[120:123], v[216:219]
    s_add_u32 m0, s77, 12288
    s_lshr_b32 s79, s67, 5
    v_mfma_f32_16x16x32_bf16 v[220:223], a[20:23], v[120:123], v[220:223]
    ds_read_b128 v[128:131], v5 offset:7168
    v_mfma_f32_16x16x32_bf16 v[224:227], a[16:19], v[116:119], v[224:227]
    buffer_load_dwordx4 v12, s[20:23], s79 offen offset:0  lds
    v_mfma_f32_16x16x32_bf16 v[228:231], a[20:23], v[116:119], v[228:231]
    ds_read_b128 v[124:127], v5 offset:8192
    s_waitcnt lgkmcnt(4)
    v_mfma_f32_16x16x32_bf16 v[232:235], a[16:19], v[112:115], v[232:235]
    v_mfma_f32_16x16x32_bf16 v[236:239], a[20:23], v[112:115], v[236:239]
    ds_read_b128 v[120:123], v5 offset:9216
    v_mfma_f32_16x16x32_bf16 v[208:211], a[24:27], v[140:143], v[208:211]
    buffer_load_dwordx4 v13, s[20:23], s79 offen offset:1024  lds
    v_mfma_f32_16x16x32_bf16 v[212:215], a[28:31], v[140:143], v[212:215]
    ds_read_b128 v[116:119], v5 offset:10240
    s_waitcnt lgkmcnt(4)
    v_mfma_f32_16x16x32_bf16 v[216:219], a[24:27], v[136:139], v[216:219]
    v_mfma_f32_16x16x32_bf16 v[220:223], a[28:31], v[136:139], v[220:223]
    ds_read_b128 v[112:115], v5 offset:11264
    v_mfma_f32_16x16x32_bf16 v[224:227], a[24:27], v[132:135], v[224:227]
    buffer_load_dwordx4 v14, s[20:23], s79 offen offset:2048  lds
    v_mfma_f32_16x16x32_bf16 v[228:231], a[28:31], v[132:135], v[228:231]
    ds_read_b128 v[140:143], v5 offset:12288
    s_waitcnt lgkmcnt(4)
    v_mfma_f32_16x16x32_bf16 v[232:235], a[24:27], v[128:131], v[232:235]
    v_mfma_f32_16x16x32_bf16 v[236:239], a[28:31], v[128:131], v[236:239]
    ds_read_b128 v[136:139], v5 offset:13312
    v_mfma_f32_16x16x32_bf16 v[144:147], a[80:83], v[124:127], v[144:147]
    buffer_load_dwordx4 v15, s[20:23], s79 offen offset:3072  lds
    v_mfma_f32_16x16x32_bf16 v[148:151], a[84:87], v[124:127], v[148:151]
    ds_read_b128 v[132:135], v5 offset:14336
    s_waitcnt lgkmcnt(4)
    v_mfma_f32_16x16x32_bf16 v[152:155], a[80:83], v[120:123], v[152:155]
    s_add_u32 m0, s5, 49152
    s_lshl_b32 s79, s63, 1
    v_mfma_f32_16x16x32_bf16 v[156:159], a[84:87], v[120:123], v[156:159]
    ds_read_b128 v[128:131], v5 offset:15360
    v_mfma_f32_16x16x32_bf16 v[160:163], a[80:83], v[116:119], v[160:163]
    buffer_load_dwordx4 v17, s[40:43], s79 offen offset:0 sc1 lds
    v_mfma_f32_16x16x32_bf16 v[164:167], a[84:87], v[116:119], v[164:167]
    ds_read_b128 v[124:127], v5 offset:16384
    s_waitcnt lgkmcnt(4)
    v_mfma_f32_16x16x32_bf16 v[168:171], a[80:83], v[112:115], v[168:171]
    v_mfma_f32_16x16x32_bf16 v[172:175], a[84:87], v[112:115], v[172:175]
    ds_read_b128 v[120:123], v5 offset:17408
    v_mfma_f32_16x16x32_bf16 v[176:179], a[80:83], v[140:143], v[176:179]
    buffer_load_dwordx4 v17, s[40:43], s79 offen offset:1024 sc1 lds
    v_mfma_f32_16x16x32_bf16 v[180:183], a[84:87], v[140:143], v[180:183]
    ds_read_b128 v[116:119], v5 offset:18432
    s_waitcnt lgkmcnt(4)
    v_mfma_f32_16x16x32_bf16 v[184:187], a[80:83], v[136:139], v[184:187]
    s_add_u32 m0, s4, 57344
    s_lshl_b32 s79, s67, 2
    v_mfma_f32_16x16x32_bf16 v[188:191], a[84:87], v[136:139], v[188:191]
    ds_read_b128 v[112:115], v5 offset:19456
    v_mfma_f32_16x16x32_bf16 v[192:195], a[80:83], v[132:135], v[192:195]
    buffer_load_dwordx4 v16, s[40:43], s79 offen offset:0 sc1 lds
    v_mfma_f32_16x16x32_bf16 v[196:199], a[84:87], v[132:135], v[196:199]
    ds_read_b128 v[140:143], v5 offset:20480
    s_waitcnt lgkmcnt(4)
    v_mfma_f32_16x16x32_bf16 v[200:203], a[80:83], v[128:131], v[200:203]
    v_mfma_f32_16x16x32_bf16 v[204:207], a[84:87], v[128:131], v[204:207]
    ds_read_b128 v[136:139], v5 offset:21504
    v_mfma_f32_16x16x32_bf16 v[144:147], a[88:91], v[124:127], v[144:147]
    buffer_load_dwordx4 v16, s[40:43], s79 offen offset:1024 sc1 lds
    v_mfma_f32_16x16x32_bf16 v[148:151], a[92:95], v[124:127], v[148:151]
    ds_read_b128 v[132:135], v5 offset:22528
    s_waitcnt lgkmcnt(4)
    v_mfma_f32_16x16x32_bf16 v[152:155], a[88:91], v[120:123], v[152:155]
    v_mfma_f32_16x16x32_bf16 v[156:159], a[92:95], v[120:123], v[156:159]
    ds_read_b128 v[128:131], v5 offset:23552
    v_mfma_f32_16x16x32_bf16 v[160:163], a[88:91], v[116:119], v[160:163]
    buffer_load_dwordx4 v16, s[40:43], s79 offen offset:2048 sc1 lds
    v_mfma_f32_16x16x32_bf16 v[164:167], a[92:95], v[116:119], v[164:167]
    s_waitcnt vmcnt(9)
    s_barrier
    ds_read_b128 v[124:127], v5 offset:24576
    s_waitcnt lgkmcnt(4)
    v_mfma_f32_16x16x32_bf16 v[168:171], a[88:91], v[112:115], v[168:171]
    v_mfma_f32_16x16x32_bf16 v[172:175], a[92:95], v[112:115], v[172:175]
    ds_read_b128 v[120:123], v5 offset:25600
    v_mfma_f32_16x16x32_bf16 v[176:179], a[88:91], v[140:143], v[176:179]
    buffer_load_dwordx4 v16, s[40:43], s79 offen offset:3072 sc1 lds
    v_mfma_f32_16x16x32_bf16 v[180:183], a[92:95], v[140:143], v[180:183]
    ds_read_b128 v[116:119], v5 offset:26624
    s_waitcnt lgkmcnt(4)
    v_mfma_f32_16x16x32_bf16 v[184:187], a[88:91], v[136:139], v[184:187]
    ds_read_b128 a[96:99], v8 offset:8192
    v_mfma_f32_16x16x32_bf16 v[188:191], a[92:95], v[136:139], v[188:191]
    ds_read_b128 v[112:115], v5 offset:27648
    ds_read_b128 a[100:103], v8 offset:10240
    v_mfma_f32_16x16x32_bf16 v[192:195], a[88:91], v[132:135], v[192:195]
    ds_read_b128 a[104:107], v9 offset:8192
    ds_read_b128 a[108:111], v9 offset:10240
    v_mfma_f32_16x16x32_bf16 v[196:199], a[92:95], v[132:135], v[196:199]
    ds_read_b128 v[140:143], v5 offset:28672
    s_waitcnt lgkmcnt(8)
    v_mfma_f32_16x16x32_bf16 v[200:203], a[88:91], v[128:131], v[200:203]
    v_mfma_f32_16x16x32_bf16 v[204:207], a[92:95], v[128:131], v[204:207]
    ds_read_b128 v[136:139], v5 offset:29696
    v_mfma_f32_16x16x32_bf16 v[208:211], a[32:35], v[124:127], v[208:211]
    v_mfma_f32_16x16x32_bf16 v[212:215], a[36:39], v[124:127], v[212:215]
    ds_read_b128 v[132:135], v5 offset:30720
    s_waitcnt lgkmcnt(8)
    v_mfma_f32_16x16x32_bf16 v[216:219], a[32:35], v[120:123], v[216:219]
    s_add_u32 m0, s77, 0
    s_lshr_b32 s79, s68, 5
    v_mfma_f32_16x16x32_bf16 v[220:223], a[36:39], v[120:123], v[220:223]
    ds_read_b128 v[128:131], v5 offset:31744
    v_mfma_f32_16x16x32_bf16 v[224:227], a[32:35], v[116:119], v[224:227]
    buffer_load_dwordx4 v12, s[20:23], s79 offen offset:0  lds
    v_mfma_f32_16x16x32_bf16 v[228:231], a[36:39], v[116:119], v[228:231]
    ds_read_b128 v[124:127], v5 offset:32768
    s_waitcnt lgkmcnt(4)
    v_mfma_f32_16x16x32_bf16 v[232:235], a[32:35], v[112:115], v[232:235]
    v_mfma_f32_16x16x32_bf16 v[236:239], a[36:39], v[112:115], v[236:239]
    ds_read_b128 v[120:123], v5 offset:33792
    v_mfma_f32_16x16x32_bf16 v[208:211], a[40:43], v[140:143], v[208:211]
    buffer_load_dwordx4 v13, s[20:23], s79 offen offset:1024  lds
    v_mfma_f32_16x16x32_bf16 v[212:215], a[44:47], v[140:143], v[212:215]
    ds_read_b128 v[116:119], v5 offset:34816
    s_waitcnt lgkmcnt(4)
    v_mfma_f32_16x16x32_bf16 v[216:219], a[40:43], v[136:139], v[216:219]
    v_mfma_f32_16x16x32_bf16 v[220:223], a[44:47], v[136:139], v[220:223]
    ds_read_b128 v[112:115], v5 offset:35840
    v_mfma_f32_16x16x32_bf16 v[224:227], a[40:43], v[132:135], v[224:227]
    buffer_load_dwordx4 v14, s[20:23], s79 offen offset:2048  lds
    v_mfma_f32_16x16x32_bf16 v[228:231], a[44:47], v[132:135], v[228:231]
    ds_read_b128 v[140:143], v5 offset:36864
    s_waitcnt lgkmcnt(4)
    v_mfma_f32_16x16x32_bf16 v[232:235], a[40:43], v[128:131], v[232:235]
    v_mfma_f32_16x16x32_bf16 v[236:239], a[44:47], v[128:131], v[236:239]
    ds_read_b128 v[136:139], v5 offset:37888
    v_mfma_f32_16x16x32_bf16 v[144:147], a[96:99], v[124:127], v[144:147]
    buffer_load_dwordx4 v15, s[20:23], s79 offen offset:3072  lds
    v_mfma_f32_16x16x32_bf16 v[148:151], a[100:103], v[124:127], v[148:151]
    ds_read_b128 v[132:135], v5 offset:38912
    s_waitcnt lgkmcnt(4)
    v_mfma_f32_16x16x32_bf16 v[152:155], a[96:99], v[120:123], v[152:155]
    s_add_u32 m0, s5, 73728
    s_lshl_b32 s79, s64, 1
    v_mfma_f32_16x16x32_bf16 v[156:159], a[100:103], v[120:123], v[156:159]
    ds_read_b128 v[128:131], v5 offset:39936
    v_mfma_f32_16x16x32_bf16 v[160:163], a[96:99], v[116:119], v[160:163]
    buffer_load_dwordx4 v17, s[40:43], s79 offen offset:0 sc1 lds
    v_mfma_f32_16x16x32_bf16 v[164:167], a[100:103], v[116:119], v[164:167]
    ds_read_b128 v[124:127], v5 offset:40960
    s_waitcnt lgkmcnt(4)
    v_mfma_f32_16x16x32_bf16 v[168:171], a[96:99], v[112:115], v[168:171]
    v_mfma_f32_16x16x32_bf16 v[172:175], a[100:103], v[112:115], v[172:175]
    ds_read_b128 v[120:123], v5 offset:41984
    v_mfma_f32_16x16x32_bf16 v[176:179], a[96:99], v[140:143], v[176:179]
    buffer_load_dwordx4 v17, s[40:43], s79 offen offset:1024 sc1 lds
    v_mfma_f32_16x16x32_bf16 v[180:183], a[100:103], v[140:143], v[180:183]
    ds_read_b128 v[116:119], v5 offset:43008
    s_waitcnt lgkmcnt(4)
    v_mfma_f32_16x16x32_bf16 v[184:187], a[96:99], v[136:139], v[184:187]
    s_add_u32 m0, s4, 81920
    s_lshl_b32 s79, s68, 2
    v_mfma_f32_16x16x32_bf16 v[188:191], a[100:103], v[136:139], v[188:191]
    ds_read_b128 v[112:115], v5 offset:44032
    v_mfma_f32_16x16x32_bf16 v[192:195], a[96:99], v[132:135], v[192:195]
    buffer_load_dwordx4 v16, s[40:43], s79 offen offset:0 sc1 lds
    v_mfma_f32_16x16x32_bf16 v[196:199], a[100:103], v[132:135], v[196:199]
    ds_read_b128 v[140:143], v5 offset:45056
    s_waitcnt lgkmcnt(4)
    v_mfma_f32_16x16x32_bf16 v[200:203], a[96:99], v[128:131], v[200:203]
    v_mfma_f32_16x16x32_bf16 v[204:207], a[100:103], v[128:131], v[204:207]
    ds_read_b128 v[136:139], v5 offset:46080
    v_mfma_f32_16x16x32_bf16 v[144:147], a[104:107], v[124:127], v[144:147]
    buffer_load_dwordx4 v16, s[40:43], s79 offen offset:1024 sc1 lds
    v_mfma_f32_16x16x32_bf16 v[148:151], a[108:111], v[124:127], v[148:151]
    ds_read_b128 v[132:135], v5 offset:47104
    s_waitcnt lgkmcnt(4)
    v_mfma_f32_16x16x32_bf16 v[152:155], a[104:107], v[120:123], v[152:155]
    v_mfma_f32_16x16x32_bf16 v[156:159], a[108:111], v[120:123], v[156:159]
    ds_read_b128 v[128:131], v5 offset:48128
    v_mfma_f32_16x16x32_bf16 v[160:163], a[104:107], v[116:119], v[160:163]
    buffer_load_dwordx4 v16, s[40:43], s79 offen offset:2048 sc1 lds
    v_mfma_f32_16x16x32_bf16 v[164:167], a[108:111], v[116:119], v[164:167]
    s_waitcnt vmcnt(9)
    s_barrier
    ds_read_b128 v[124:127], v5 offset:49152
    s_waitcnt lgkmcnt(4)
    v_mfma_f32_16x16x32_bf16 v[168:171], a[104:107], v[112:115], v[168:171]
    v_mfma_f32_16x16x32_bf16 v[172:175], a[108:111], v[112:115], v[172:175]
    ds_read_b128 v[120:123], v5 offset:50176
    v_mfma_f32_16x16x32_bf16 v[176:179], a[104:107], v[140:143], v[176:179]
    buffer_load_dwordx4 v16, s[40:43], s79 offen offset:3072 sc1 lds
    v_mfma_f32_16x16x32_bf16 v[180:183], a[108:111], v[140:143], v[180:183]
    ds_read_b128 v[116:119], v5 offset:51200
    s_waitcnt lgkmcnt(4)
    v_mfma_f32_16x16x32_bf16 v[184:187], a[104:107], v[136:139], v[184:187]
    ds_read_b128 a[112:115], v8 offset:12288
    v_mfma_f32_16x16x32_bf16 v[188:191], a[108:111], v[136:139], v[188:191]
    ds_read_b128 v[112:115], v5 offset:52224
    ds_read_b128 a[116:119], v8 offset:14336
    v_mfma_f32_16x16x32_bf16 v[192:195], a[104:107], v[132:135], v[192:195]
    ds_read_b128 a[120:123], v9 offset:12288
    ds_read_b128 a[124:127], v9 offset:14336
    v_mfma_f32_16x16x32_bf16 v[196:199], a[108:111], v[132:135], v[196:199]
    ds_read_b128 v[140:143], v5 offset:53248
    s_waitcnt lgkmcnt(8)
    v_mfma_f32_16x16x32_bf16 v[200:203], a[104:107], v[128:131], v[200:203]
    v_mfma_f32_16x16x32_bf16 v[204:207], a[108:111], v[128:131], v[204:207]
    ds_read_b128 v[136:139], v5 offset:54272
    v_mfma_f32_16x16x32_bf16 v[208:211], a[48:51], v[124:127], v[208:211]
    v_mfma_f32_16x16x32_bf16 v[212:215], a[52:55], v[124:127], v[212:215]
    ds_read_b128 v[132:135], v5 offset:55296
    s_waitcnt lgkmcnt(8)
    v_mfma_f32_16x16x32_bf16 v[216:219], a[48:51], v[120:123], v[216:219]
    s_add_u32 m0, s77, 4096
    s_lshr_b32 s79, s69, 5
    v_mfma_f32_16x16x32_bf16 v[220:223], a[52:55], v[120:123], v[220:223]
    ds_read_b128 v[128:131], v5 offset:56320
    v_mfma_f32_16x16x32_bf16 v[224:227], a[48:51], v[116:119], v[224:227]
    buffer_load_dwordx4 v12, s[20:23], s79 offen offset:0  lds
    v_mfma_f32_16x16x32_bf16 v[228:231], a[52:55], v[116:119], v[228:231]
    ds_read_b128 v[124:127], v5 offset:57344
    s_waitcnt lgkmcnt(4)
    v_mfma_f32_16x16x32_bf16 v[232:235], a[48:51], v[112:115], v[232:235]
    v_mfma_f32_16x16x32_bf16 v[236:239], a[52:55], v[112:115], v[236:239]
    ds_read_b128 v[120:123], v5 offset:58368
    v_mfma_f32_16x16x32_bf16 v[208:211], a[56:59], v[140:143], v[208:211]
    buffer_load_dwordx4 v13, s[20:23], s79 offen offset:1024  lds
    v_mfma_f32_16x16x32_bf16 v[212:215], a[60:63], v[140:143], v[212:215]
    ds_read_b128 v[116:119], v5 offset:59392
    s_waitcnt lgkmcnt(4)
    v_mfma_f32_16x16x32_bf16 v[216:219], a[56:59], v[136:139], v[216:219]
    v_mfma_f32_16x16x32_bf16 v[220:223], a[60:63], v[136:139], v[220:223]
    ds_read_b128 v[112:115], v5 offset:60416
    v_mfma_f32_16x16x32_bf16 v[224:227], a[56:59], v[132:135], v[224:227]
    buffer_load_dwordx4 v14, s[20:23], s79 offen offset:2048  lds
    v_mfma_f32_16x16x32_bf16 v[228:231], a[60:63], v[132:135], v[228:231]
    ds_read_b128 v[140:143], v5 offset:61440
    s_waitcnt lgkmcnt(4)
    v_mfma_f32_16x16x32_bf16 v[232:235], a[56:59], v[128:131], v[232:235]
    v_mfma_f32_16x16x32_bf16 v[236:239], a[60:63], v[128:131], v[236:239]
    ds_read_b128 v[136:139], v5 offset:62464
    v_mfma_f32_16x16x32_bf16 v[144:147], a[112:115], v[124:127], v[144:147]
    buffer_load_dwordx4 v15, s[20:23], s79 offen offset:3072  lds
    v_mfma_f32_16x16x32_bf16 v[148:151], a[116:119], v[124:127], v[148:151]
    ds_read_b128 v[132:135], v5 offset:63488
    s_waitcnt lgkmcnt(4)
    v_mfma_f32_16x16x32_bf16 v[152:155], a[112:115], v[120:123], v[152:155]
    s_add_u32 m0, s5, 0
    s_lshl_b32 s79, s65, 1
    v_mfma_f32_16x16x32_bf16 v[156:159], a[116:119], v[120:123], v[156:159]
    ds_read_b128 v[128:131], v5 offset:64512
    v_mfma_f32_16x16x32_bf16 v[160:163], a[112:115], v[116:119], v[160:163]
    buffer_load_dwordx4 v17, s[40:43], s79 offen offset:0 sc1 lds
    v_mfma_f32_16x16x32_bf16 v[164:167], a[116:119], v[116:119], v[164:167]
    ds_read_b128 v[124:127], v6 offset:0
    s_waitcnt lgkmcnt(4)
    v_mfma_f32_16x16x32_bf16 v[168:171], a[112:115], v[112:115], v[168:171]
    v_mfma_f32_16x16x32_bf16 v[172:175], a[116:119], v[112:115], v[172:175]
    ds_read_b128 v[120:123], v6 offset:1024
    v_mfma_f32_16x16x32_bf16 v[176:179], a[112:115], v[140:143], v[176:179]
    buffer_load_dwordx4 v17, s[40:43], s79 offen offset:1024 sc1 lds
    v_mfma_f32_16x16x32_bf16 v[180:183], a[116:119], v[140:143], v[180:183]
    ds_read_b128 v[116:119], v6 offset:2048
    s_waitcnt lgkmcnt(4)
    v_mfma_f32_16x16x32_bf16 v[184:187], a[112:115], v[136:139], v[184:187]
    s_add_u32 m0, s4, 8192
    s_lshl_b32 s79, s69, 2
    v_mfma_f32_16x16x32_bf16 v[188:191], a[116:119], v[136:139], v[188:191]
    ds_read_b128 v[112:115], v6 offset:3072
    v_mfma_f32_16x16x32_bf16 v[192:195], a[112:115], v[132:135], v[192:195]
    buffer_load_dwordx4 v16, s[40:43], s79 offen offset:0 sc1 lds
    v_mfma_f32_16x16x32_bf16 v[196:199], a[116:119], v[132:135], v[196:199]
    ds_read_b128 v[140:143], v6 offset:4096
    s_waitcnt lgkmcnt(4)
    v_mfma_f32_16x16x32_bf16 v[200:203], a[112:115], v[128:131], v[200:203]
    v_mfma_f32_16x16x32_bf16 v[204:207], a[116:119], v[128:131], v[204:207]
    ds_read_b128 v[136:139], v6 offset:5120
    v_mfma_f32_16x16x32_bf16 v[144:147], a[120:123], v[124:127], v[144:147]
    buffer_load_dwordx4 v16, s[40:43], s79 offen offset:1024 sc1 lds
    v_mfma_f32_16x16x32_bf16 v[148:151], a[124:127], v[124:127], v[148:151]
    ds_read_b128 v[132:135], v6 offset:6144
    s_waitcnt lgkmcnt(4)
    v_mfma_f32_16x16x32_bf16 v[152:155], a[120:123], v[120:123], v[152:155]
    v_mfma_f32_16x16x32_bf16 v[156:159], a[124:127], v[120:123], v[156:159]
    ds_read_b128 v[128:131], v6 offset:7168
    v_mfma_f32_16x16x32_bf16 v[160:163], a[120:123], v[116:119], v[160:163]
    buffer_load_dwordx4 v16, s[40:43], s79 offen offset:2048 sc1 lds
    v_mfma_f32_16x16x32_bf16 v[164:167], a[124:127], v[116:119], v[164:167]
    s_waitcnt vmcnt(9)
    s_barrier
    ds_read_b128 v[124:127], v6 offset:8192
    s_waitcnt lgkmcnt(4)
    v_mfma_f32_16x16x32_bf16 v[168:171], a[120:123], v[112:115], v[168:171]
    v_mfma_f32_16x16x32_bf16 v[172:175], a[124:127], v[112:115], v[172:175]
    ds_read_b128 v[120:123], v6 offset:9216
    v_mfma_f32_16x16x32_bf16 v[176:179], a[120:123], v[140:143], v[176:179]
    buffer_load_dwordx4 v16, s[40:43], s79 offen offset:3072 sc1 lds
    v_mfma_f32_16x16x32_bf16 v[180:183], a[124:127], v[140:143], v[180:183]
    ds_read_b128 v[116:119], v6 offset:10240
    s_waitcnt lgkmcnt(4)
    v_mfma_f32_16x16x32_bf16 v[184:187], a[120:123], v[136:139], v[184:187]
    ds_read_b128 a[128:131], v8 offset:0
    v_mfma_f32_16x16x32_bf16 v[188:191], a[124:127], v[136:139], v[188:191]
    ds_read_b128 v[112:115], v6 offset:11264
    ds_read_b128 a[132:135], v8 offset:2048
    v_mfma_f32_16x16x32_bf16 v[192:195], a[120:123], v[132:135], v[192:195]
    ds_read_b128 a[136:139], v9 offset:0
    ds_read_b128 a[140:143], v9 offset:2048
    v_mfma_f32_16x16x32_bf16 v[196:199], a[124:127], v[132:135], v[196:199]
    ds_read_b128 v[140:143], v6 offset:12288
    s_waitcnt lgkmcnt(8)
    v_mfma_f32_16x16x32_bf16 v[200:203], a[120:123], v[128:131], v[200:203]
    v_mfma_f32_16x16x32_bf16 v[204:207], a[124:127], v[128:131], v[204:207]
    ds_read_b128 v[136:139], v6 offset:13312
    v_mfma_f32_16x16x32_bf16 v[208:211], a[64:67], v[124:127], v[208:211]
    v_mfma_f32_16x16x32_bf16 v[212:215], a[68:71], v[124:127], v[212:215]
    ds_read_b128 v[132:135], v6 offset:14336
    s_waitcnt lgkmcnt(8)
    v_mfma_f32_16x16x32_bf16 v[216:219], a[64:67], v[120:123], v[216:219]
    s_add_u32 m0, s77, 8192
    s_lshr_b32 s79, s70, 5
    v_mfma_f32_16x16x32_bf16 v[220:223], a[68:71], v[120:123], v[220:223]
    ds_read_b128 v[128:131], v6 offset:15360
    v_mfma_f32_16x16x32_bf16 v[224:227], a[64:67], v[116:119], v[224:227]
    buffer_load_dwordx4 v12, s[20:23], s79 offen offset:0  lds
    v_mfma_f32_16x16x32_bf16 v[228:231], a[68:71], v[116:119], v[228:231]
    ds_read_b128 v[124:127], v6 offset:16384
    s_waitcnt lgkmcnt(4)
    v_mfma_f32_16x16x32_bf16 v[232:235], a[64:67], v[112:115], v[232:235]
    v_mfma_f32_16x16x32_bf16 v[236:239], a[68:71], v[112:115], v[236:239]
    ds_read_b128 v[120:123], v6 offset:17408
    v_mfma_f32_16x16x32_bf16 v[208:211], a[72:75], v[140:143], v[208:211]
    buffer_load_dwordx4 v13, s[20:23], s79 offen offset:1024  lds
    v_mfma_f32_16x16x32_bf16 v[212:215], a[76:79], v[140:143], v[212:215]
    ds_read_b128 v[116:119], v6 offset:18432
    s_waitcnt lgkmcnt(4)
    v_mfma_f32_16x16x32_bf16 v[216:219], a[72:75], v[136:139], v[216:219]
    v_mfma_f32_16x16x32_bf16 v[220:223], a[76:79], v[136:139], v[220:223]
    ds_read_b128 v[112:115], v6 offset:19456
    v_mfma_f32_16x16x32_bf16 v[224:227], a[72:75], v[132:135], v[224:227]
    buffer_load_dwordx4 v14, s[20:23], s79 offen offset:2048  lds
    v_mfma_f32_16x16x32_bf16 v[228:231], a[76:79], v[132:135], v[228:231]
    ds_read_b128 v[140:143], v6 offset:20480
    s_waitcnt lgkmcnt(4)
    v_mfma_f32_16x16x32_bf16 v[232:235], a[72:75], v[128:131], v[232:235]
    v_mfma_f32_16x16x32_bf16 v[236:239], a[76:79], v[128:131], v[236:239]
    ds_read_b128 v[136:139], v6 offset:21504
    v_mfma_f32_16x16x32_bf16 v[144:147], a[128:131], v[124:127], v[144:147]
    buffer_load_dwordx4 v15, s[20:23], s79 offen offset:3072  lds
    v_mfma_f32_16x16x32_bf16 v[148:151], a[132:135], v[124:127], v[148:151]
    ds_read_b128 v[132:135], v6 offset:22528
    s_waitcnt lgkmcnt(4)
    v_mfma_f32_16x16x32_bf16 v[152:155], a[128:131], v[120:123], v[152:155]
    s_add_u32 m0, s5, 24576
    s_lshl_b32 s79, s66, 1
    v_mfma_f32_16x16x32_bf16 v[156:159], a[132:135], v[120:123], v[156:159]
    ds_read_b128 v[128:131], v6 offset:23552
    v_mfma_f32_16x16x32_bf16 v[160:163], a[128:131], v[116:119], v[160:163]
    buffer_load_dwordx4 v17, s[40:43], s79 offen offset:0 sc1 lds
    v_mfma_f32_16x16x32_bf16 v[164:167], a[132:135], v[116:119], v[164:167]
    ds_read_b128 v[124:127], v6 offset:24576
    s_waitcnt lgkmcnt(4)
    v_mfma_f32_16x16x32_bf16 v[168:171], a[128:131], v[112:115], v[168:171]
    v_mfma_f32_16x16x32_bf16 v[172:175], a[132:135], v[112:115], v[172:175]
    ds_read_b128 v[120:123], v6 offset:25600
    v_mfma_f32_16x16x32_bf16 v[176:179], a[128:131], v[140:143], v[176:179]
    buffer_load_dwordx4 v17, s[40:43], s79 offen offset:1024 sc1 lds
    v_mfma_f32_16x16x32_bf16 v[180:183], a[132:135], v[140:143], v[180:183]
L_pad3:
    s_cbranch_execz L_back
    ds_read_b128 v[116:119], v6 offset:26624
    s_waitcnt lgkmcnt(4)
    v_mfma_f32_16x16x32_bf16 v[184:187], a[128:131], v[136:139], v[184:187]
    s_add_u32 m0, s4, 32768
    s_lshl_b32 s79, s70, 2
    v_mfma_f32_16x16x32_bf16 v[188:191], a[132:135], v[136:139], v[188:191]
    ds_read_b128 v[112:115], v6 offset:27648
    v_mfma_f32_16x16x32_bf16 v[192:195], a[128:131], v[132:135], v[192:195]
    buffer_load_dwordx4 v16, s[40:43], s79 offen offset:0 sc1 lds
    v_mfma_f32_16x16x32_bf16 v[196:199], a[132:135], v[132:135], v[196:199]
    ds_read_b128 v[140:143], v6 offset:28672
    s_waitcnt lgkmcnt(4)
    v_mfma_f32_16x16x32_bf16 v[200:203], a[128:131], v[128:131], v[200:203]
    v_mfma_f32_16x16x32_bf16 v[204:207], a[132:135], v[128:131], v[204:207]
    ds_read_b128 v[136:139], v6 offset:29696
    v_mfma_f32_16x16x32_bf16 v[144:147], a[136:139], v[124:127], v[144:147]
    buffer_load_dwordx4 v16, s[40:43], s79 offen offset:1024 sc1 lds
    v_mfma_f32_16x16x32_bf16 v[148:151], a[140:143], v[124:127], v[148:151]
    ds_read_b128 v[132:135], v6 offset:30720
    s_waitcnt lgkmcnt(4)
    v_mfma_f32_16x16x32_bf16 v[152:155], a[136:139], v[120:123], v[152:155]
    v_mfma_f32_16x16x32_bf16 v[156:159], a[140:143], v[120:123], v[156:159]
    ds_read_b128 v[128:131], v6 offset:31744
    v_mfma_f32_16x16x32_bf16 v[160:163], a[136:139], v[116:119], v[160:163]
    buffer_load_dwordx4 v16, s[40:43], s79 offen offset:2048 sc1 lds
    v_mfma_f32_16x16x32_bf16 v[164:167], a[140:143], v[116:119], v[164:167]
    s_waitcnt vmcnt(9)
    s_barrier
    ds_read_b128 v[124:127], v5 offset:0
    s_waitcnt lgkmcnt(4)
    v_mfma_f32_16x16x32_bf16 v[168:171], a[136:139], v[112:115], v[168:171]
    v_mfma_f32_16x16x32_bf16 v[172:175], a[140:143], v[112:115], v[172:175]
    ds_read_b128 v[120:123], v5 offset:1024
    v_mfma_f32_16x16x32_bf16 v[176:179], a[136:139], v[140:143], v[176:179]
    buffer_load_dwordx4 v16, s[40:43], s79 offen offset:3072 sc1 lds
    v_mfma_f32_16x16x32_bf16 v[180:183], a[140:143], v[140:143], v[180:183]
    ds_read_b128 v[116:119], v5 offset:2048
    s_waitcnt lgkmcnt(4)
    v_mfma_f32_16x16x32_bf16 v[184:187], a[136:139], v[136:139], v[184:187]
    ds_read_b128 a[144:147], v8 offset:4096
    v_mfma_f32_16x16x32_bf16 v[188:191], a[140:143], v[136:139], v[188:191]
    ds_read_b128 v[112:115], v5 offset:3072
    ds_read_b128 a[148:151], v8 offset:6144
    v_mfma_f32_16x16x32_bf16 v[192:195], a[136:139], v[132:135], v[192:195]
    ds_read_b128 a[152:155], v9 offset:4096
    ds_read_b128 a[156:159], v9 offset:6144
    v_mfma_f32_16x16x32_bf16 v[196:199], a[140:143], v[132:135], v[196:199]
    ds_read_b128 v[140:143], v5 offset:4096
    s_waitcnt lgkmcnt(8)
    v_mfma_f32_16x16x32_bf16 v[200:203], a[136:139], v[128:131], v[200:203]
    v_mfma_f32_16x16x32_bf16 v[204:207], a[140:143], v[128:131], v[204:207]
    ds_read_b128 v[136:139], v5 offset:5120
    v_mfma_f32_16x16x32_bf16 v[208:211], a[80:83], v[124:127], v[208:211]
    v_mfma_f32_16x16x32_bf16 v[212:215], a[84:87], v[124:127], v[212:215]
    ds_read_b128 v[132:135], v5 offset:6144
    s_waitcnt lgkmcnt(8)
    v_mfma_f32_16x16x32_bf16 v[216:219], a[80:83], v[120:123], v[216:219]
    s_add_u32 m0, s77, 12288
    s_lshr_b32 s79, s71, 5
    v_mfma_f32_16x16x32_bf16 v[220:223], a[84:87], v[120:123], v[220:223]
    ds_read_b128 v[128:131], v5 offset:7168
    v_mfma_f32_16x16x32_bf16 v[224:227], a[80:83], v[116:119], v[224:227]
    buffer_load_dwordx4 v12, s[20:23], s79 offen offset:0  lds
    v_mfma_f32_16x16x32_bf16 v[228:231], a[84:87], v[116:119], v[228:231]
    ds_read_b128 v[124:127], v5 offset:8192
    s_waitcnt lgkmcnt(4)
    v_mfma_f32_16x16x32_bf16 v[232:235], a[80:83], v[112:115], v[232:235]
    v_mfma_f32_16x16x32_bf16 v[236:239], a[84:87], v[112:115], v[236:239]
    ds_read_b128 v[120:123], v5 offset:9216
    v_mfma_f32_16x16x32_bf16 v[208:211], a[88:91], v[140:143], v[208:211]
    buffer_load_dwordx4 v13, s[20:23], s79 offen offset:1024  lds
    v_mfma_f32_16x16x32_bf16 v[212:215], a[92:95], v[140:143], v[212:215]
    ds_read_b128 v[116:119], v5 offset:10240
    s_waitcnt lgkmcnt(4)
    v_mfma_f32_16x16x32_bf16 v[216:219], a[88:91], v[136:139], v[216:219]
    v_mfma_f32_16x16x32_bf16 v[220:223], a[92:95], v[136:139], v[220:223]
    ds_read_b128 v[112:115], v5 offset:11264
    v_mfma_f32_16x16x32_bf16 v[224:227], a[88:91], v[132:135], v[224:227]
    buffer_load_dwordx4 v14, s[20:23], s79 offen offset:2048  lds
    v_mfma_f32_16x16x32_bf16 v[228:231], a[92:95], v[132:135], v[228:231]
    ds_read_b128 v[140:143], v5 offset:12288
    s_waitcnt lgkmcnt(4)
    v_mfma_f32_16x16x32_bf16 v[232:235], a[88:91], v[128:131], v[232:235]
    v_mfma_f32_16x16x32_bf16 v[236:239], a[92:95], v[128:131], v[236:239]
    ds_read_b128 v[136:139], v5 offset:13312
    v_mfma_f32_16x16x32_bf16 v[144:147], a[144:147], v[124:127], v[144:147]
    buffer_load_dwordx4 v15, s[20:23], s79 offen offset:3072  lds
    v_mfma_f32_16x16x32_bf16 v[148:151], a[148:151], v[124:127], v[148:151]
    ds_read_b128 v[132:135], v5 offset:14336
    s_waitcnt lgkmcnt(4)
    v_mfma_f32_16x16x32_bf16 v[152:155], a[144:147], v[120:123], v[152:155]
    s_add_u32 m0, s5, 49152
    s_lshl_b32 s79, s67, 1
    v_mfma_f32_16x16x32_bf16 v[156:159], a[148:151], v[120:123], v[156:159]
    ds_read_b128 v[128:131], v5 offset:15360
    v_mfma_f32_16x16x32_bf16 v[160:163], a[144:147], v[116:119], v[160:163]
    buffer_load_dwordx4 v17, s[40:43], s79 offen offset:0 sc1 lds
    v_mfma_f32_16x16x32_bf16 v[164:167], a[148:151], v[116:119], v[164:167]
    ds_read_b128 v[124:127], v5 offset:16384
    s_waitcnt lgkmcnt(4)
    v_mfma_f32_16x16x32_bf16 v[168:171], a[144:147], v[112:115], v[168:171]
    v_mfma_f32_16x16x32_bf16 v[172:175], a[148:151], v[112:115], v[172:175]
    ds_read_b128 v[120:123], v5 offset:17408
    v_mfma_f32_16x16x32_bf16 v[176:179], a[144:147], v[140:143], v[176:179]
    buffer_load_dwordx4 v17, s[40:43], s79 offen offset:1024 sc1 lds
    v_mfma_f32_16x16x32_bf16 v[180:183], a[148:151], v[140:143], v[180:183]
    ds_read_b128 v[116:119], v5 offset:18432
    s_waitcnt lgkmcnt(4)
    v_mfma_f32_16x16x32_bf16 v[184:187], a[144:147], v[136:139], v[184:187]
    s_add_u32 m0, s4, 57344
    s_lshl_b32 s79, s71, 2
    v_mfma_f32_16x16x32_bf16 v[188:191], a[148:151], v[136:139], v[188:191]
    ds_read_b128 v[112:115], v5 offset:19456
    v_mfma_f32_16x16x32_bf16 v[192:195], a[144:147], v[132:135], v[192:195]
    buffer_load_dwordx4 v16, s[40:43], s79 offen offset:0 sc1 lds
    v_mfma_f32_16x16x32_bf16 v[196:199], a[148:151], v[132:135], v[196:199]
    ds_read_b128 v[140:143], v5 offset:20480
    s_waitcnt lgkmcnt(4)
    v_mfma_f32_16x16x32_bf16 v[200:203], a[144:147], v[128:131], v[200:203]
    v_mfma_f32_16x16x32_bf16 v[204:207], a[148:151], v[128:131], v[204:207]
    ds_read_b128 v[136:139], v5 offset:21504
    v_mfma_f32_16x16x32_bf16 v[144:147], a[152:155], v[124:127], v[144:147]
    buffer_load_dwordx4 v16, s[40:43], s79 offen offset:1024 sc1 lds
    v_mfma_f32_16x16x32_bf16 v[148:151], a[156:159], v[124:127], v[148:151]
    ds_read_b128 v[132:135], v5 offset:22528
    s_waitcnt lgkmcnt(4)
    v_mfma_f32_16x16x32_bf16 v[152:155], a[152:155], v[120:123], v[152:155]
    v_mfma_f32_16x16x32_bf16 v[156:159], a[156:159], v[120:123], v[156:159]
    ds_read_b128 v[128:131], v5 offset:23552
    v_mfma_f32_16x16x32_bf16 v[160:163], a[152:155], v[116:119], v[160:163]
    buffer_load_dwordx4 v16, s[40:43], s79 offen offset:2048 sc1 lds
    v_mfma_f32_16x16x32_bf16 v[164:167], a[156:159], v[116:119], v[164:167]
    s_waitcnt vmcnt(9)
    s_barrier
    ds_read_b128 v[124:127], v5 offset:24576
    s_waitcnt lgkmcnt(4)
    v_mfma_f32_16x16x32_bf16 v[168:171], a[152:155], v[112:115], v[168:171]
    v_mfma_f32_16x16x32_bf16 v[172:175], a[156:159], v[112:115], v[172:175]
    ds_read_b128 v[120:123], v5 offset:25600
    v_mfma_f32_16x16x32_bf16 v[176:179], a[152:155], v[140:143], v[176:179]
    buffer_load_dwordx4 v16, s[40:43], s79 offen offset:3072 sc1 lds
    v_mfma_f32_16x16x32_bf16 v[180:183], a[156:159], v[140:143], v[180:183]
    ds_read_b128 v[116:119], v5 offset:26624
    s_waitcnt lgkmcnt(4)
    v_mfma_f32_16x16x32_bf16 v[184:187], a[152:155], v[136:139], v[184:187]
    ds_read_b128 a[160:163], v8 offset:8192
    v_mfma_f32_16x16x32_bf16 v[188:191], a[156:159], v[136:139], v[188:191]
    ds_read_b128 v[112:115], v5 offset:27648
    ds_read_b128 a[164:167], v8 offset:10240
    v_mfma_f32_16x16x32_bf16 v[192:195], a[152:155], v[132:135], v[192:195]
    ds_read_b128 a[168:171], v9 offset:8192
    ds_read_b128 a[172:175], v9 offset:10240
    v_mfma_f32_16x16x32_bf16 v[196:199], a[156:159], v[132:135], v[196:199]
    ds_read_b128 v[140:143], v5 offset:28672
    s_waitcnt lgkmcnt(8)
    v_mfma_f32_16x16x32_bf16 v[200:203], a[152:155], v[128:131], v[200:203]
    v_mfma_f32_16x16x32_bf16 v[204:207], a[156:159], v[128:131], v[204:207]
    ds_read_b128 v[136:139], v5 offset:29696
    v_mfma_f32_16x16x32_bf16 v[208:211], a[96:99], v[124:127], v[208:211]
    v_mfma_f32_16x16x32_bf16 v[212:215], a[100:103], v[124:127], v[212:215]
    ds_read_b128 v[132:135], v5 offset:30720
    s_waitcnt lgkmcnt(8)
    v_mfma_f32_16x16x32_bf16 v[216:219], a[96:99], v[120:123], v[216:219]
    s_add_u32 m0, s77, 0
    s_lshr_b32 s79, s72, 5
    v_mfma_f32_16x16x32_bf16 v[220:223], a[100:103], v[120:123], v[220:223]
    ds_read_b128 v[128:131], v5 offset:31744
    v_mfma_f32_16x16x32_bf16 v[224:227], a[96:99], v[116:119], v[224:227]
    buffer_load_dwordx4 v12, s[20:23], s79 offen offset:0  lds
    v_mfma_f32_16x16x32_bf16 v[228:231], a[100:103], v[116:119], v[228:231]
    ds_read_b128 v[124:127], v5 offset:32768
    s_waitcnt lgkmcnt(4)
    v_mfma_f32_16x16x32_bf16 v[232:235], a[96:99], v[112:115], v[232:235]
    v_mfma_f32_16x16x32_bf16 v[236:239], a[100:103], v[112:115], v[236:239]
    ds_read_b128 v[120:123], v5 offset:33792
    v_mfma_f32_16x16x32_bf16 v[208:211], a[104:107], v[140:143], v[208:211]
    buffer_load_dwordx4 v13, s[20:23], s79 offen offset:1024  lds
    v_mfma_f32_16x16x32_bf16 v[212:215], a[108:111], v[140:143], v[212:215]
    ds_read_b128 v[116:119], v5 offset:34816
    s_waitcnt lgkmcnt(4)
    v_mfma_f32_16x16x32_bf16 v[216:219], a[104:107], v[136:139], v[216:219]
    v_mfma_f32_16x16x32_bf16 v[220:223], a[108:111], v[136:139], v[220:223]
    ds_read_b128 v[112:115], v5 offset:35840
    v_mfma_f32_16x16x32_bf16 v[224:227], a[104:107], v[132:135], v[224:227]
    buffer_load_dwordx4 v14, s[20:23], s79 offen offset:2048  lds
    v_mfma_f32_16x16x32_bf16 v[228:231], a[108:111], v[132:135], v[228:231]
    ds_read_b128 v[140:143], v5 offset:36864
    s_waitcnt lgkmcnt(4)
    v_mfma_f32_16x16x32_bf16 v[232:235], a[104:107], v[128:131], v[232:235]
    v_mfma_f32_16x16x32_bf16 v[236:239], a[108:111], v[128:131], v[236:239]
    ds_read_b128 v[136:139], v5 offset:37888
    v_mfma_f32_16x16x32_bf16 v[144:147], a[160:163], v[124:127], v[144:147]
    buffer_load_dwordx4 v15, s[20:23], s79 offen offset:3072  lds
    v_mfma_f32_16x16x32_bf16 v[148:151], a[164:167], v[124:127], v[148:151]
    ds_read_b128 v[132:135], v5 offset:38912
    s_waitcnt lgkmcnt(4)
    v_mfma_f32_16x16x32_bf16 v[152:155], a[160:163], v[120:123], v[152:155]
    s_add_u32 m0, s5, 73728
    s_lshl_b32 s79, s68, 1
    v_mfma_f32_16x16x32_bf16 v[156:159], a[164:167], v[120:123], v[156:159]
    ds_read_b128 v[128:131], v5 offset:39936
    v_mfma_f32_16x16x32_bf16 v[160:163], a[160:163], v[116:119], v[160:163]
    buffer_load_dwordx4 v17, s[40:43], s79 offen offset:0 sc1 lds
    v_mfma_f32_16x16x32_bf16 v[164:167], a[164:167], v[116:119], v[164:167]
    ds_read_b128 v[124:127], v5 offset:40960
    s_waitcnt lgkmcnt(4)
    v_mfma_f32_16x16x32_bf16 v[168:171], a[160:163], v[112:115], v[168:171]
    v_mfma_f32_16x16x32_bf16 v[172:175], a[164:167], v[112:115], v[172:175]
    ds_read_b128 v[120:123], v5 offset:41984
    v_mfma_f32_16x16x32_bf16 v[176:179], a[160:163], v[140:143], v[176:179]
    buffer_load_dwordx4 v17, s[40:43], s79 offen offset:1024 sc1 lds
    v_mfma_f32_16x16x32_bf16 v[180:183], a[164:167], v[140:143], v[180:183]
    ds_read_b128 v[116:119], v5 offset:43008
    s_waitcnt lgkmcnt(4)
    v_mfma_f32_16x16x32_bf16 v[184:187], a[160:163], v[136:139], v[184:187]
    s_add_u32 m0, s4, 81920
    s_lshl_b32 s79, s72, 2
    v_mfma_f32_16x16x32_bf16 v[188:191], a[164:167], v[136:139], v[188:191]
    ds_read_b128 v[112:115], v5 offset:44032
    v_mfma_f32_16x16x32_bf16 v[192:195], a[160:163], v[132:135], v[192:195]
    buffer_load_dwordx4 v16, s[40:43], s79 offen offset:0 sc1 lds
    v_mfma_f32_16x16x32_bf16 v[196:199], a[164:167], v[132:135], v[196:199]
    ds_read_b128 v[140:143], v5 offset:45056
    s_waitcnt lgkmcnt(4)
    v_mfma_f32_16x16x32_bf16 v[200:203], a[160:163], v[128:131], v[200:203]
    v_mfma_f32_16x16x32_bf16 v[204:207], a[164:167], v[128:131], v[204:207]
    ds_read_b128 v[136:139], v5 offset:46080
    v_mfma_f32_16x16x32_bf16 v[144:147], a[168:171], v[124:127], v[144:147]
    buffer_load_dwordx4 v16, s[40:43], s79 offen offset:1024 sc1 lds
    v_mfma_f32_16x16x32_bf16 v[148:151], a[172:175], v[124:127], v[148:151]
    ds_read_b128 v[132:135], v5 offset:47104
    s_waitcnt lgkmcnt(4)
    v_mfma_f32_16x16x32_bf16 v[152:155], a[168:171], v[120:123], v[152:155]
    v_mfma_f32_16x16x32_bf16 v[156:159], a[172:175], v[120:123], v[156:159]
    ds_read_b128 v[128:131], v5 offset:48128
    v_mfma_f32_16x16x32_bf16 v[160:163], a[168:171], v[116:119], v[160:163]
    buffer_load_dwordx4 v16, s[40:43], s79 offen offset:2048 sc1 lds
    v_mfma_f32_16x16x32_bf16 v[164:167], a[172:175], v[116:119], v[164:167]
    s_waitcnt vmcnt(9)
    s_barrier
    ds_read_b128 v[124:127], v5 offset:49152
    s_waitcnt lgkmcnt(4)
    v_mfma_f32_16x16x32_bf16 v[168:171], a[168:171], v[112:115], v[168:171]
    v_mfma_f32_16x16x32_bf16 v[172:175], a[172:175], v[112:115], v[172:175]
    ds_read_b128 v[120:123], v5 offset:50176
    v_mfma_f32_16x16x32_bf16 v[176:179], a[168:171], v[140:143], v[176:179]
    buffer_load_dwordx4 v16, s[40:43], s79 offen offset:3072 sc1 lds
    v_mfma_f32_16x16x32_bf16 v[180:183], a[172:175], v[140:143], v[180:183]
    ds_read_b128 v[116:119], v5 offset:51200
    s_waitcnt lgkmcnt(4)
    v_mfma_f32_16x16x32_bf16 v[184:187], a[168:171], v[136:139], v[184:187]
    ds_read_b128 a[176:179], v8 offset:12288
    v_mfma_f32_16x16x32_bf16 v[188:191], a[172:175], v[136:139], v[188:191]
    ds_read_b128 v[112:115], v5 offset:52224
    ds_read_b128 a[180:183], v8 offset:14336
    v_mfma_f32_16x16x32_bf16 v[192:195], a[168:171], v[132:135], v[192:195]
    ds_read_b128 a[184:187], v9 offset:12288
    ds_read_b128 a[188:191], v9 offset:14336
    v_mfma_f32_16x16x32_bf16 v[196:199], a[172:175], v[132:135], v[196:199]
    ds_read_b128 v[140:143], v5 offset:53248
    s_waitcnt lgkmcnt(8)
    v_mfma_f32_16x16x32_bf16 v[200:203], a[168:171], v[128:131], v[200:203]
    v_mfma_f32_16x16x32_bf16 v[204:207], a[172:175], v[128:131], v[204:207]
    ds_read_b128 v[136:139], v5 offset:54272
    v_mfma_f32_16x16x32_bf16 v[208:211], a[112:115], v[124:127], v[208:211]
    v_mfma_f32_16x16x32_bf16 v[212:215], a[116:119], v[124:127], v[212:215]
    ds_read_b128 v[132:135], v5 offset:55296
    s_waitcnt lgkmcnt(8)
    v_mfma_f32_16x16x32_bf16 v[216:219], a[112:115], v[120:123], v[216:219]
    s_add_u32 m0, s77, 4096
    s_lshr_b32 s79, s73, 5
    v_mfma_f32_16x16x32_bf16 v[220:223], a[116:119], v[120:123], v[220:223]
    ds_read_b128 v[128:131], v5 offset:56320
    v_mfma_f32_16x16x32_bf16 v[224:227], a[112:115], v[116:119], v[224:227]
    buffer_load_dwordx4 v12, s[20:23], s79 offen offset:0  lds
    v_mfma_f32_16x16x32_bf16 v[228:231], a[116:119], v[116:119], v[228:231]
    ds_read_b128 v[124:127], v5 offset:57344
    s_waitcnt lgkmcnt(4)
    v_mfma_f32_16x16x32_bf16 v[232:235], a[112:115], v[112:115], v[232:235]
    v_mfma_f32_16x16x32_bf16 v[236:239], a[116:119], v[112:115], v[236:239]
    ds_read_b128 v[120:123], v5 offset:58368
    v_mfma_f32_16x16x32_bf16 v[208:211], a[120:123], v[140:143], v[208:211]
    buffer_load_dwordx4 v13, s[20:23], s79 offen offset:1024  lds
    v_mfma_f32_16x16x32_bf16 v[212:215], a[124:127], v[140:143], v[212:215]
    ds_read_b128 v[116:119], v5 offset:59392
    s_waitcnt lgkmcnt(4)
    v_mfma_f32_16x16x32_bf16 v[216:219], a[120:123], v[136:139], v[216:219]
    v_mfma_f32_16x16x32_bf16 v[220:223], a[124:127], v[136:139], v[220:223]
    ds_read_b128 v[112:115], v5 offset:60416
    v_mfma_f32_16x16x32_bf16 v[224:227], a[120:123], v[132:135], v[224:227]
    buffer_load_dwordx4 v14, s[20:23], s79 offen offset:2048  lds
    v_mfma_f32_16x16x32_bf16 v[228:231], a[124:127], v[132:135], v[228:231]
    ds_read_b128 v[140:143], v5 offset:61440
    s_waitcnt lgkmcnt(4)
    v_mfma_f32_16x16x32_bf16 v[232:235], a[120:123], v[128:131], v[232:235]
    v_mfma_f32_16x16x32_bf16 v[236:239], a[124:127], v[128:131], v[236:239]
    ds_read_b128 v[136:139], v5 offset:62464
    v_mfma_f32_16x16x32_bf16 v[144:147], a[176:179], v[124:127], v[144:147]
    buffer_load_dwordx4 v15, s[20:23], s79 offen offset:3072  lds
    v_mfma_f32_16x16x32_bf16 v[148:151], a[180:183], v[124:127], v[148:151]
    ds_read_b128 v[132:135], v5 offset:63488
    s_waitcnt lgkmcnt(4)
    v_mfma_f32_16x16x32_bf16 v[152:155], a[176:179], v[120:123], v[152:155]
    s_add_u32 m0, s5, 0
    s_lshl_b32 s79, s69, 1
    v_mfma_f32_16x16x32_bf16 v[156:159], a[180:183], v[120:123], v[156:159]
    ds_read_b128 v[128:131], v5 offset:64512
    v_mfma_f32_16x16x32_bf16 v[160:163], a[176:179], v[116:119], v[160:163]
    buffer_load_dwordx4 v17, s[40:43], s79 offen offset:0 sc1 lds
    v_mfma_f32_16x16x32_bf16 v[164:167], a[180:183], v[116:119], v[164:167]
    ds_read_b128 v[124:127], v6 offset:0
    s_waitcnt lgkmcnt(4)
    v_mfma_f32_16x16x32_bf16 v[168:171], a[176:179], v[112:115], v[168:171]
    v_mfma_f32_16x16x32_bf16 v[172:175], a[180:183], v[112:115], v[172:175]
    ds_read_b128 v[120:123], v6 offset:1024
    v_mfma_f32_16x16x32_bf16 v[176:179], a[176:179], v[140:143], v[176:179]
    buffer_load_dwordx4 v17, s[40:43], s79 offen offset:1024 sc1 lds
    v_mfma_f32_16x16x32_bf16 v[180:183], a[180:183], v[140:143], v[180:183]
    ds_read_b128 v[116:119], v6 offset:2048
    s_waitcnt lgkmcnt(4)
    v_mfma_f32_16x16x32_bf16 v[184:187], a[176:179], v[136:139], v[184:187]
    s_add_u32 m0, s4, 8192
    s_lshl_b32 s79, s73, 2
    v_mfma_f32_16x16x32_bf16 v[188:191], a[180:183], v[136:139], v[188:191]
    ds_read_b128 v[112:115], v6 offset:3072
    v_mfma_f32_16x16x32_bf16 v[192:195], a[176:179], v[132:135], v[192:195]
    buffer_load_dwordx4 v16, s[40:43], s79 offen offset:0 sc1 lds
    v_mfma_f32_16x16x32_bf16 v[196:199], a[180:183], v[132:135], v[196:199]
    ds_read_b128 v[140:143], v6 offset:4096
    s_waitcnt lgkmcnt(4)
    v_mfma_f32_16x16x32_bf16 v[200:203], a[176:179], v[128:131], v[200:203]
    v_mfma_f32_16x16x32_bf16 v[204:207], a[180:183], v[128:131], v[204:207]
    ds_read_b128 v[136:139], v6 offset:5120
    v_mfma_f32_16x16x32_bf16 v[144:147], a[184:187], v[124:127], v[144:147]
    buffer_load_dwordx4 v16, s[40:43], s79 offen offset:1024 sc1 lds
    v_mfma_f32_16x16x32_bf16 v[148:151], a[188:191], v[124:127], v[148:151]
    ds_read_b128 v[132:135], v6 offset:6144
    s_waitcnt lgkmcnt(4)
    v_mfma_f32_16x16x32_bf16 v[152:155], a[184:187], v[120:123], v[152:155]
    v_mfma_f32_16x16x32_bf16 v[156:159], a[188:191], v[120:123], v[156:159]
    ds_read_b128 v[128:131], v6 offset:7168
    v_mfma_f32_16x16x32_bf16 v[160:163], a[184:187], v[116:119], v[160:163]
    buffer_load_dwordx4 v16, s[40:43], s79 offen offset:2048 sc1 lds
    v_mfma_f32_16x16x32_bf16 v[164:167], a[188:191], v[116:119], v[164:167]
    s_waitcnt vmcnt(9)
    s_barrier
    ds_read_b128 v[124:127], v6 offset:8192
    s_waitcnt lgkmcnt(4)
    v_mfma_f32_16x16x32_bf16 v[168:171], a[184:187], v[112:115], v[168:171]
    v_mfma_f32_16x16x32_bf16 v[172:175], a[188:191], v[112:115], v[172:175]
    ds_read_b128 v[120:123], v6 offset:9216
    v_mfma_f32_16x16x32_bf16 v[176:179], a[184:187], v[140:143], v[176:179]
    buffer_load_dwordx4 v16, s[40:43], s79 offen offset:3072 sc1 lds
    v_mfma_f32_16x16x32_bf16 v[180:183], a[188:191], v[140:143], v[180:183]
    ds_read_b128 v[116:119], v6 offset:10240
    s_waitcnt lgkmcnt(4)
    v_mfma_f32_16x16x32_bf16 v[184:187], a[184:187], v[136:139], v[184:187]
    ds_read_b128 a[192:195], v8 offset:0
    v_mfma_f32_16x16x32_bf16 v[188:191], a[188:191], v[136:139], v[188:191]
    ds_read_b128 v[112:115], v6 offset:11264
    ds_read_b128 a[196:199], v8 offset:2048
    v_mfma_f32_16x16x32_bf16 v[192:195], a[184:187], v[132:135], v[192:195]
    ds_read_b128 a[200:203], v9 offset:0
    ds_read_b128 a[204:207], v9 offset:2048
    v_mfma_f32_16x16x32_bf16 v[196:199], a[188:191], v[132:135], v[196:199]
    ds_read_b128 v[140:143], v6 offset:12288
    s_waitcnt lgkmcnt(8)
    v_mfma_f32_16x16x32_bf16 v[200:203], a[184:187], v[128:131], v[200:203]
    s_add_u32 m0, s5, 24576
    s_lshl_b32 s79, s70, 1
    v_mfma_f32_16x16x32_bf16 v[204:207], a[188:191], v[128:131], v[204:207]
    ds_read_b128 v[136:139], v6 offset:13312
    v_mfma_f32_16x16x32_bf16 v[208:211], a[128:131], v[124:127], v[208:211]
    buffer_load_dwordx4 v17, s[40:43], s79 offen offset:0 sc1 lds
    v_mfma_f32_16x16x32_bf16 v[212:215], a[132:135], v[124:127], v[212:215]
    ds_read_b128 v[132:135], v6 offset:14336
    s_waitcnt lgkmcnt(8)
    v_mfma_f32_16x16x32_bf16 v[216:219], a[128:131], v[120:123], v[216:219]
    v_mfma_f32_16x16x32_bf16 v[220:223], a[132:135], v[120:123], v[220:223]
    ds_read_b128 v[128:131], v6 offset:15360
    v_mfma_f32_16x16x32_bf16 v[224:227], a[128:131], v[116:119], v[224:227]
    buffer_load_dwordx4 v17, s[40:43], s79 offen offset:1024 sc1 lds
    v_mfma_f32_16x16x32_bf16 v[228:231], a[132:135], v[116:119], v[228:231]
    ds_read_b128 v[124:127], v6 offset:16384
    s_waitcnt lgkmcnt(4)
    v_mfma_f32_16x16x32_bf16 v[232:235], a[128:131], v[112:115], v[232:235]
    s_add_u32 m0, s77, 8192
    s_lshr_b32 s79, s74, 5
    v_mfma_f32_16x16x32_bf16 v[236:239], a[132:135], v[112:115], v[236:239]
    ds_read_b128 v[120:123], v6 offset:17408
    v_mfma_f32_16x16x32_bf16 v[208:211], a[136:139], v[140:143], v[208:211]
    buffer_load_dwordx4 v12, s[20:23], s79 offen offset:0  lds
    v_mfma_f32_16x16x32_bf16 v[212:215], a[140:143], v[140:143], v[212:215]
    ds_read_b128 v[116:119], v6 offset:18432
    s_waitcnt lgkmcnt(4)
    v_mfma_f32_16x16x32_bf16 v[216:219], a[136:139], v[136:139], v[216:219]
    v_mfma_f32_16x16x32_bf16 v[220:223], a[140:143], v[136:139], v[220:223]
    ds_read_b128 v[112:115], v6 offset:19456
    v_mfma_f32_16x16x32_bf16 v[224:227], a[136:139], v[132:135], v[224:227]
    buffer_load_dwordx4 v13, s[20:23], s79 offen offset:1024  lds
    v_mfma_f32_16x16x32_bf16 v[228:231], a[140:143], v[132:135], v[228:231]
    ds_read_b128 v[140:143], v6 offset:20480
    s_waitcnt lgkmcnt(4)
    v_mfma_f32_16x16x32_bf16 v[232:235], a[136:139], v[128:131], v[232:235]
    v_mfma_f32_16x16x32_bf16 v[236:239], a[140:143], v[128:131], v[236:239]
    ds_read_b128 v[136:139], v6 offset:21504
    v_mfma_f32_16x16x32_bf16 v[144:147], a[192:195], v[124:127], v[144:147]
    buffer_load_dwordx4 v14, s[20:23], s79 offen offset:2048  lds
    v_mfma_f32_16x16x32_bf16 v[148:151], a[196:199], v[124:127], v[148:151]
    ds_read_b128 v[132:135], v6 offset:22528
    s_waitcnt lgkmcnt(4)
    v_mfma_f32_16x16x32_bf16 v[152:155], a[192:195], v[120:123], v[152:155]
    v_mfma_f32_16x16x32_bf16 v[156:159], a[196:199], v[120:123], v[156:159]
    ds_read_b128 v[128:131], v6 offset:23552
    v_mfma_f32_16x16x32_bf16 v[160:163], a[192:195], v[116:119], v[160:163]
    buffer_load_dwordx4 v15, s[20:23], s79 offen offset:3072  lds
    v_mfma_f32_16x16x32_bf16 v[164:167], a[196:199], v[116:119], v[164:167]
    ds_read_b128 v[124:127], v6 offset:24576
    s_waitcnt lgkmcnt(4)
    v_mfma_f32_16x16x32_bf16 v[168:171], a[192:195], v[112:115], v[168:171]
    s_add_u32 m0, s4, 32768
    s_lshl_b32 s79, s74, 2
    v_mfma_f32_16x16x32_bf16 v[172:175], a[196:199], v[112:115], v[172:175]
    ds_read_b128 v[120:123], v6 offset:25600
    v_mfma_f32_16x16x32_bf16 v[176:179], a[192:195], v[140:143], v[176:179]
    buffer_load_dwordx4 v16, s[40:43], s79 offen offset:0 sc1 lds
    v_mfma_f32_16x16x32_bf16 v[180:183], a[196:199], v[140:143], v[180:183]
    ds_read_b128 v[116:119], v6 offset:26624
    s_waitcnt lgkmcnt(4)
    v_mfma_f32_16x16x32_bf16 v[184:187], a[192:195], v[136:139], v[184:187]
    v_mfma_f32_16x16x32_bf16 v[188:191], a[196:199], v[136:139], v[188:191]
    ds_read_b128 v[112:115], v6 offset:27648
    v_mfma_f32_16x16x32_bf16 v[192:195], a[192:195], v[132:135], v[192:195]
    buffer_load_dwordx4 v16, s[40:43], s79 offen offset:1024 sc1 lds
    v_mfma_f32_16x16x32_bf16 v[196:199], a[196:199], v[132:135], v[196:199]
    ds_read_b128 v[140:143], v6 offset:28672
    s_waitcnt lgkmcnt(4)
    v_mfma_f32_16x16x32_bf16 v[200:203], a[192:195], v[128:131], v[200:203]
    v_mfma_f32_16x16x32_bf16 v[204:207], a[196:199], v[128:131], v[204:207]
    ds_read_b128 v[136:139], v6 offset:29696
    v_mfma_f32_16x16x32_bf16 v[144:147], a[200:203], v[124:127], v[144:147]
    buffer_load_dwordx4 v16, s[40:43], s79 offen offset:2048 sc1 lds
    v_mfma_f32_16x16x32_bf16 v[148:151], a[204:207], v[124:127], v[148:151]
    ds_read_b128 v[132:135], v6 offset:30720
    s_waitcnt lgkmcnt(4)
    v_mfma_f32_16x16x32_bf16 v[152:155], a[200:203], v[120:123], v[152:155]
    v_mfma_f32_16x16x32_bf16 v[156:159], a[204:207], v[120:123], v[156:159]
    ds_read_b128 v[128:131], v6 offset:31744
    v_mfma_f32_16x16x32_bf16 v[160:163], a[200:203], v[116:119], v[160:163]
    buffer_load_dwordx4 v16, s[40:43], s79 offen offset:3072 sc1 lds
    v_mfma_f32_16x16x32_bf16 v[164:167], a[204:207], v[116:119], v[164:167]
    s_waitcnt vmcnt(10)
    s_barrier
    ds_read_b128 v[124:127], v5 offset:0
    s_waitcnt lgkmcnt(4)
    v_mfma_f32_16x16x32_bf16 v[168:171], a[200:203], v[112:115], v[168:171]
    s_add_u32 m0, s5, 49152
    s_lshl_b32 s79, s71, 1
    v_mfma_f32_16x16x32_bf16 v[172:175], a[204:207], v[112:115], v[172:175]
    ds_read_b128 v[120:123], v5 offset:1024
    v_mfma_f32_16x16x32_bf16 v[176:179], a[200:203], v[140:143], v[176:179]
    buffer_load_dwordx4 v17, s[40:43], s79 offen offset:0 sc1 lds
    v_mfma_f32_16x16x32_bf16 v[180:183], a[204:207], v[140:143], v[180:183]
    ds_read_b128 v[116:119], v5 offset:2048
    s_waitcnt lgkmcnt(4)
    v_mfma_f32_16x16x32_bf16 v[184:187], a[200:203], v[136:139], v[184:187]
    v_mfma_f32_16x16x32_bf16 v[188:191], a[204:207], v[136:139], v[188:191]
    ds_read_b128 v[112:115], v5 offset:3072
    v_mfma_f32_16x16x32_bf16 v[192:195], a[200:203], v[132:135], v[192:195]
    buffer_load_dwordx4 v17, s[40:43], s79 offen offset:1024 sc1 lds
    v_mfma_f32_16x16x32_bf16 v[196:199], a[204:207], v[132:135], v[196:199]
    ds_read_b128 v[140:143], v5 offset:4096
    s_waitcnt lgkmcnt(4)
    v_mfma_f32_16x16x32_bf16 v[200:203], a[200:203], v[128:131], v[200:203]
    ds_read_b128 a[208:211], v8 offset:4096
    v_mfma_f32_16x16x32_bf16 v[204:207], a[204:207], v[128:131], v[204:207]
    ds_read_b128 v[136:139], v5 offset:5120
    ds_read_b128 a[212:215], v8 offset:6144
    v_mfma_f32_16x16x32_bf16 v[208:211], a[144:147], v[124:127], v[208:211]
    ds_read_b128 a[216:219], v9 offset:4096
    ds_read_b128 a[220:223], v9 offset:6144
    v_mfma_f32_16x16x32_bf16 v[212:215], a[148:151], v[124:127], v[212:215]
    ds_read_b128 v[132:135], v5 offset:6144
    s_waitcnt lgkmcnt(8)
    v_mfma_f32_16x16x32_bf16 v[216:219], a[144:147], v[120:123], v[216:219]
    s_add_u32 m0, s77, 12288
    s_lshr_b32 s79, s75, 5
    v_mfma_f32_16x16x32_bf16 v[220:223], a[148:151], v[120:123], v[220:223]
    ds_read_b128 v[128:131], v5 offset:7168
    v_mfma_f32_16x16x32_bf16 v[224:227], a[144:147], v[116:119], v[224:227]
    buffer_load_dwordx4 v12, s[20:23], s79 offen offset:0  lds
    v_mfma_f32_16x16x32_bf16 v[228:231], a[148:151], v[116:119], v[228:231]
    ds_read_b128 v[124:127], v5 offset:8192
    s_waitcnt lgkmcnt(8)
    v_mfma_f32_16x16x32_bf16 v[232:235], a[144:147], v[112:115], v[232:235]
    v_mfma_f32_16x16x32_bf16 v[236:239], a[148:151], v[112:115], v[236:239]
    ds_read_b128 v[120:123], v5 offset:9216
    v_mfma_f32_16x16x32_bf16 v[208:211], a[152:155], v[140:143], v[208:211]
    buffer_load_dwordx4 v13, s[20:23], s79 offen offset:1024  lds
    v_mfma_f32_16x16x32_bf16 v[212:215], a[156:159], v[140:143], v[212:215]
    ds_read_b128 v[116:119], v5 offset:10240
    s_waitcnt lgkmcnt(4)
    v_mfma_f32_16x16x32_bf16 v[216:219], a[152:155], v[136:139], v[216:219]
    v_mfma_f32_16x16x32_bf16 v[220:223], a[156:159], v[136:139], v[220:223]
    ds_read_b128 v[112:115], v5 offset:11264
    v_mfma_f32_16x16x32_bf16 v[224:227], a[152:155], v[132:135], v[224:227]
    buffer_load_dwordx4 v14, s[20:23], s79 offen offset:2048  lds
    v_mfma_f32_16x16x32_bf16 v[228:231], a[156:159], v[132:135], v[228:231]
    ds_read_b128 v[140:143], v5 offset:12288
    s_waitcnt lgkmcnt(4)
    v_mfma_f32_16x16x32_bf16 v[232:235], a[152:155], v[128:131], v[232:235]
    v_mfma_f32_16x16x32_bf16 v[236:239], a[156:159], v[128:131], v[236:239]
    ds_read_b128 v[136:139], v5 offset:13312
    v_mfma_f32_16x16x32_bf16 v[144:147], a[208:211], v[124:127], v[144:147]
    buffer_load_dwordx4 v15, s[20:23], s79 offen offset:3072  lds
    v_mfma_f32_16x16x32_bf16 v[148:151], a[212:215], v[124:127], v[148:151]
    ds_read_b128 v[132:135], v5 offset:14336
    s_waitcnt lgkmcnt(4)
    v_mfma_f32_16x16x32_bf16 v[152:155], a[208:211], v[120:123], v[152:155]
    s_add_u32 m0, s4, 57344
    s_lshl_b32 s79, s75, 2
    v_mfma_f32_16x16x32_bf16 v[156:159], a[212:215], v[120:123], v[156:159]
    ds_read_b128 v[128:131], v5 offset:15360
    v_mfma_f32_16x16x32_bf16 v[160:163], a[208:211], v[116:119], v[160:163]
    buffer_load_dwordx4 v16, s[40:43], s79 offen offset:0 sc1 lds
    v_mfma_f32_16x16x32_bf16 v[164:167], a[212:215], v[116:119], v[164:167]
    ds_read_b128 v[124:127], v5 offset:16384
    s_waitcnt lgkmcnt(4)
    v_mfma_f32_16x16x32_bf16 v[168:171], a[208:211], v[112:115], v[168:171]
    v_mfma_f32_16x16x32_bf16 v[172:175], a[212:215], v[112:115], v[172:175]
    ds_read_b128 v[120:123], v5 offset:17408
    v_mfma_f32_16x16x32_bf16 v[176:179], a[208:211], v[140:143], v[176:179]
    buffer_load_dwordx4 v16, s[40:43], s79 offen offset:1024 sc1 lds
    v_mfma_f32_16x16x32_bf16 v[180:183], a[212:215], v[140:143], v[180:183]
    ds_read_b128 v[116:119], v5 offset:18432
    s_waitcnt lgkmcnt(4)
    v_mfma_f32_16x16x32_bf16 v[184:187], a[208:211], v[136:139], v[184:187]
    v_mfma_f32_16x16x32_bf16 v[188:191], a[212:215], v[136:139], v[188:191]
    ds_read_b128 v[112:115], v5 offset:19456
    v_mfma_f32_16x16x32_bf16 v[192:195], a[208:211], v[132:135], v[192:195]
    buffer_load_dwordx4 v16, s[40:43], s79 offen offset:2048 sc1 lds
    v_mfma_f32_16x16x32_bf16 v[196:199], a[212:215], v[132:135], v[196:199]
    ds_read_b128 v[140:143], v5 offset:20480
    s_waitcnt lgkmcnt(4)
    v_mfma_f32_16x16x32_bf16 v[200:203], a[208:211], v[128:131], v[200:203]
    v_mfma_f32_16x16x32_bf16 v[204:207], a[212:215], v[128:131], v[204:207]
    ds_read_b128 v[136:139], v5 offset:21504
    v_mfma_f32_16x16x32_bf16 v[144:147], a[216:219], v[124:127], v[144:147]
    buffer_load_dwordx4 v16, s[40:43], s79 offen offset:3072 sc1 lds
    v_mfma_f32_16x16x32_bf16 v[148:151], a[220:223], v[124:127], v[148:151]
    ds_read_b128 v[132:135], v5 offset:22528
    s_waitcnt lgkmcnt(4)
    v_mfma_f32_16x16x32_bf16 v[152:155], a[216:219], v[120:123], v[152:155]
    s_add_u32 m0, s5, 73728
    s_lshl_b32 s79, s72, 1
    v_mfma_f32_16x16x32_bf16 v[156:159], a[220:223], v[120:123], v[156:159]
    ds_read_b128 v[128:131], v5 offset:23552
L_pad4:
    s_cbranch_execz L_back
    v_mfma_f32_16x16x32_bf16 v[160:163], a[216:219], v[116:119], v[160:163]
    buffer_load_dwordx4 v17, s[40:43], s79 offen offset:0 sc1 lds
    v_mfma_f32_16x16x32_bf16 v[164:167], a[220:223], v[116:119], v[164:167]
    s_waitcnt vmcnt(11)
    s_barrier
    ds_read_b128 v[124:127], v5 offset:24576
    s_waitcnt lgkmcnt(4)
    v_mfma_f32_16x16x32_bf16 v[168:171], a[216:219], v[112:115], v[168:171]
    v_mfma_f32_16x16x32_bf16 v[172:175], a[220:223], v[112:115], v[172:175]
    ds_read_b128 v[120:123], v5 offset:25600
    v_mfma_f32_16x16x32_bf16 v[176:179], a[216:219], v[140:143], v[176:179]
    buffer_load_dwordx4 v17, s[40:43], s79 offen offset:1024 sc1 lds
    v_mfma_f32_16x16x32_bf16 v[180:183], a[220:223], v[140:143], v[180:183]
    ds_read_b128 v[116:119], v5 offset:26624
    s_waitcnt lgkmcnt(4)
    v_mfma_f32_16x16x32_bf16 v[184:187], a[216:219], v[136:139], v[184:187]
    ds_read_b128 a[224:227], v8 offset:8192
    v_mfma_f32_16x16x32_bf16 v[188:191], a[220:223], v[136:139], v[188:191]
    ds_read_b128 v[112:115], v5 offset:27648
    ds_read_b128 a[228:231], v8 offset:10240
    v_mfma_f32_16x16x32_bf16 v[192:195], a[216:219], v[132:135], v[192:195]
    ds_read_b128 a[232:235], v9 offset:8192
    ds_read_b128 a[236:239], v9 offset:10240
    v_mfma_f32_16x16x32_bf16 v[196:199], a[220:223], v[132:135], v[196:199]
    ds_read_b128 v[140:143], v5 offset:28672
    s_waitcnt lgkmcnt(8)
    v_mfma_f32_16x16x32_bf16 v[200:203], a[216:219], v[128:131], v[200:203]
    s_add_u32 m0, s5, 81920
    s_lshl_b32 s79, s73, 1
    v_mfma_f32_16x16x32_bf16 v[204:207], a[220:223], v[128:131], v[204:207]
    ds_read_b128 v[136:139], v5 offset:29696
    v_mfma_f32_16x16x32_bf16 v[208:211], a[160:163], v[124:127], v[208:211]
    buffer_load_dwordx4 v17, s[40:43], s79 offen offset:0 sc1 lds
    v_mfma_f32_16x16x32_bf16 v[212:215], a[164:167], v[124:127], v[212:215]
    ds_read_b128 v[132:135], v5 offset:30720
    s_waitcnt lgkmcnt(8)
    v_mfma_f32_16x16x32_bf16 v[216:219], a[160:163], v[120:123], v[216:219]
    v_mfma_f32_16x16x32_bf16 v[220:223], a[164:167], v[120:123], v[220:223]
    ds_read_b128 v[128:131], v5 offset:31744
    v_mfma_f32_16x16x32_bf16 v[224:227], a[160:163], v[116:119], v[224:227]
    buffer_load_dwordx4 v17, s[40:43], s79 offen offset:1024 sc1 lds
    v_mfma_f32_16x16x32_bf16 v[228:231], a[164:167], v[116:119], v[228:231]
    ds_read_b128 v[124:127], v5 offset:32768
    s_waitcnt lgkmcnt(4)
    v_mfma_f32_16x16x32_bf16 v[232:235], a[160:163], v[112:115], v[232:235]
    s_add_u32 m0, s5, 90112
    s_lshl_b32 s79, s74, 1
    v_mfma_f32_16x16x32_bf16 v[236:239], a[164:167], v[112:115], v[236:239]
    ds_read_b128 v[120:123], v5 offset:33792
    v_mfma_f32_16x16x32_bf16 v[208:211], a[168:171], v[140:143], v[208:211]
    buffer_load_dwordx4 v17, s[40:43], s79 offen offset:0 sc1 lds
    v_mfma_f32_16x16x32_bf16 v[212:215], a[172:175], v[140:143], v[212:215]
    ds_read_b128 v[116:119], v5 offset:34816
    s_waitcnt lgkmcnt(4)
    v_mfma_f32_16x16x32_bf16 v[216:219], a[168:171], v[136:139], v[216:219]
    v_mfma_f32_16x16x32_bf16 v[220:223], a[172:175], v[136:139], v[220:223]
    ds_read_b128 v[112:115], v5 offset:35840
    v_mfma_f32_16x16x32_bf16 v[224:227], a[168:171], v[132:135], v[224:227]
    buffer_load_dwordx4 v17, s[40:43], s79 offen offset:1024 sc1 lds
    v_mfma_f32_16x16x32_bf16 v[228:231], a[172:175], v[132:135], v[228:231]
    ds_read_b128 v[140:143], v5 offset:36864
    s_waitcnt lgkmcnt(4)
    v_mfma_f32_16x16x32_bf16 v[232:235], a[168:171], v[128:131], v[232:235]
    s_add_u32 m0, s5, 0
    s_lshl_b32 s79, s75, 1
    v_mfma_f32_16x16x32_bf16 v[236:239], a[172:175], v[128:131], v[236:239]
    ds_read_b128 v[136:139], v5 offset:37888
    v_mfma_f32_16x16x32_bf16 v[144:147], a[224:227], v[124:127], v[144:147]
    buffer_load_dwordx4 v17, s[40:43], s79 offen offset:0 sc1 lds
    v_mfma_f32_16x16x32_bf16 v[148:151], a[228:231], v[124:127], v[148:151]
    ds_read_b128 v[132:135], v5 offset:38912
    s_waitcnt lgkmcnt(4)
    v_mfma_f32_16x16x32_bf16 v[152:155], a[224:227], v[120:123], v[152:155]
    v_mfma_f32_16x16x32_bf16 v[156:159], a[228:231], v[120:123], v[156:159]
    ds_read_b128 v[128:131], v5 offset:39936
    v_mfma_f32_16x16x32_bf16 v[160:163], a[224:227], v[116:119], v[160:163]
    buffer_load_dwordx4 v17, s[40:43], s79 offen offset:1024 sc1 lds
    v_mfma_f32_16x16x32_bf16 v[164:167], a[228:231], v[116:119], v[164:167]
    ds_read_b128 v[124:127], v5 offset:40960
    s_waitcnt lgkmcnt(4)
    v_mfma_f32_16x16x32_bf16 v[168:171], a[224:227], v[112:115], v[168:171]
    v_mfma_f32_16x16x32_bf16 v[172:175], a[228:231], v[112:115], v[172:175]
    ds_read_b128 v[120:123], v5 offset:41984
    v_mfma_f32_16x16x32_bf16 v[176:179], a[224:227], v[140:143], v[176:179]
    v_mfma_f32_16x16x32_bf16 v[180:183], a[228:231], v[140:143], v[180:183]
    ds_read_b128 v[116:119], v5 offset:43008
    s_waitcnt lgkmcnt(4)
    v_mfma_f32_16x16x32_bf16 v[184:187], a[224:227], v[136:139], v[184:187]
    v_mfma_f32_16x16x32_bf16 v[188:191], a[228:231], v[136:139], v[188:191]
    ds_read_b128 v[112:115], v5 offset:44032
    v_mfma_f32_16x16x32_bf16 v[192:195], a[224:227], v[132:135], v[192:195]
    v_mfma_f32_16x16x32_bf16 v[196:199], a[228:231], v[132:135], v[196:199]
    ds_read_b128 v[140:143], v5 offset:45056
    s_waitcnt lgkmcnt(4)
    v_mfma_f32_16x16x32_bf16 v[200:203], a[224:227], v[128:131], v[200:203]
    v_mfma_f32_16x16x32_bf16 v[204:207], a[228:231], v[128:131], v[204:207]
    ds_read_b128 v[136:139], v5 offset:46080
    v_mfma_f32_16x16x32_bf16 v[144:147], a[232:235], v[124:127], v[144:147]
    v_mfma_f32_16x16x32_bf16 v[148:151], a[236:239], v[124:127], v[148:151]
    ds_read_b128 v[132:135], v5 offset:47104
    s_waitcnt lgkmcnt(4)
    v_mfma_f32_16x16x32_bf16 v[152:155], a[232:235], v[120:123], v[152:155]
    v_mfma_f32_16x16x32_bf16 v[156:159], a[236:239], v[120:123], v[156:159]
    ds_read_b128 v[128:131], v5 offset:48128
    v_mfma_f32_16x16x32_bf16 v[160:163], a[232:235], v[116:119], v[160:163]
    v_mfma_f32_16x16x32_bf16 v[164:167], a[236:239], v[116:119], v[164:167]
    s_waitcnt vmcnt(8)
    s_barrier
    ds_read_b128 v[124:127], v5 offset:49152
    s_waitcnt lgkmcnt(4)
    v_mfma_f32_16x16x32_bf16 v[168:171], a[232:235], v[112:115], v[168:171]
    s_add_u32 m0, s6, 8192
    s_nop 0
    v_mfma_f32_16x16x32_bf16 v[172:175], a[236:239], v[112:115], v[172:175]
    ds_read_b128 v[120:123], v5 offset:50176
    v_mfma_f32_16x16x32_bf16 v[176:179], a[232:235], v[140:143], v[176:179]
    buffer_load_dwordx4 v18, s[40:43], s61 offen offset:0 sc1 lds
    v_mfma_f32_16x16x32_bf16 v[180:183], a[236:239], v[140:143], v[180:183]
    ds_read_b128 v[116:119], v5 offset:51200
    s_waitcnt lgkmcnt(4)
    v_mfma_f32_16x16x32_bf16 v[184:187], a[232:235], v[136:139], v[184:187]
    ds_read_b128 a[240:243], v8 offset:12288
    v_mfma_f32_16x16x32_bf16 v[188:191], a[236:239], v[136:139], v[188:191]
    ds_read_b128 v[112:115], v5 offset:52224
    ds_read_b128 a[244:247], v8 offset:14336
    v_mfma_f32_16x16x32_bf16 v[192:195], a[232:235], v[132:135], v[192:195]
    ds_read_b128 a[248:251], v9 offset:12288
    ds_read_b128 a[252:255], v9 offset:14336
    v_mfma_f32_16x16x32_bf16 v[196:199], a[236:239], v[132:135], v[196:199]
    ds_read_b128 v[140:143], v5 offset:53248
    s_waitcnt lgkmcnt(8)
    v_mfma_f32_16x16x32_bf16 v[200:203], a[232:235], v[128:131], v[200:203]
    s_add_u32 m0, s6, 12288
    s_nop 0
    v_mfma_f32_16x16x32_bf16 v[204:207], a[236:239], v[128:131], v[204:207]
    ds_read_b128 v[136:139], v5 offset:54272
    v_mfma_f32_16x16x32_bf16 v[208:211], a[176:179], v[124:127], v[208:211]
    buffer_load_dwordx4 v18, s[40:43], s62 offen offset:0 sc1 lds
    v_mfma_f32_16x16x32_bf16 v[212:215], a[180:183], v[124:127], v[212:215]
    ds_read_b128 v[132:135], v5 offset:55296
    s_waitcnt lgkmcnt(8)
    v_mfma_f32_16x16x32_bf16 v[216:219], a[176:179], v[120:123], v[216:219]
    s_add_u32 m0, s6, 16384
    s_nop 0
    v_mfma_f32_16x16x32_bf16 v[220:223], a[180:183], v[120:123], v[220:223]
    ds_read_b128 v[128:131], v5 offset:56320
    v_mfma_f32_16x16x32_bf16 v[224:227], a[176:179], v[116:119], v[224:227]
    buffer_load_dwordx4 v18, s[40:43], s63 offen offset:0 sc1 lds
    v_mfma_f32_16x16x32_bf16 v[228:231], a[180:183], v[116:119], v[228:231]
    ds_read_b128 v[124:127], v5 offset:57344
    s_waitcnt lgkmcnt(4)
    v_mfma_f32_16x16x32_bf16 v[232:235], a[176:179], v[112:115], v[232:235]
    s_add_u32 m0, s6, 20480
    s_nop 0
    v_mfma_f32_16x16x32_bf16 v[236:239], a[180:183], v[112:115], v[236:239]
    ds_read_b128 v[120:123], v5 offset:58368
    v_mfma_f32_16x16x32_bf16 v[208:211], a[184:187], v[140:143], v[208:211]
    buffer_load_dwordx4 v18, s[40:43], s64 offen offset:0 sc1 lds
    v_mfma_f32_16x16x32_bf16 v[212:215], a[188:191], v[140:143], v[212:215]
    ds_read_b128 v[116:119], v5 offset:59392
    s_waitcnt lgkmcnt(4)
    v_mfma_f32_16x16x32_bf16 v[216:219], a[184:187], v[136:139], v[216:219]
    s_add_u32 m0, s6, 24576
    s_nop 0
    v_mfma_f32_16x16x32_bf16 v[220:223], a[188:191], v[136:139], v[220:223]
    ds_read_b128 v[112:115], v5 offset:60416
    v_mfma_f32_16x16x32_bf16 v[224:227], a[184:187], v[132:135], v[224:227]
    buffer_load_dwordx4 v18, s[40:43], s65 offen offset:0 sc1 lds
    v_mfma_f32_16x16x32_bf16 v[228:231], a[188:191], v[132:135], v[228:231]
    ds_read_b128 v[140:143], v5 offset:61440
    s_waitcnt lgkmcnt(4)
    v_mfma_f32_16x16x32_bf16 v[232:235], a[184:187], v[128:131], v[232:235]
    s_add_u32 m0, s6, 28672
    s_nop 0
    v_mfma_f32_16x16x32_bf16 v[236:239], a[188:191], v[128:131], v[236:239]
    ds_read_b128 v[136:139], v5 offset:62464
    v_mfma_f32_16x16x32_bf16 v[144:147], a[240:243], v[124:127], v[144:147]
    buffer_load_dwordx4 v18, s[40:43], s66 offen offset:0 sc1 lds
    v_mfma_f32_16x16x32_bf16 v[148:151], a[244:247], v[124:127], v[148:151]
    ds_read_b128 v[132:135], v5 offset:63488
    s_waitcnt lgkmcnt(4)
    v_mfma_f32_16x16x32_bf16 v[152:155], a[240:243], v[120:123], v[152:155]
    v_mfma_f32_16x16x32_bf16 v[156:159], a[244:247], v[120:123], v[156:159]
    ds_read_b128 v[128:131], v5 offset:64512
    v_mfma_f32_16x16x32_bf16 v[160:163], a[240:243], v[116:119], v[160:163]
    v_mfma_f32_16x16x32_bf16 v[164:167], a[244:247], v[116:119], v[164:167]
    ds_read_b128 v[124:127], v6 offset:0
    s_waitcnt lgkmcnt(4)
    v_mfma_f32_16x16x32_bf16 v[168:171], a[240:243], v[112:115], v[168:171]
    v_mfma_f32_16x16x32_bf16 v[172:175], a[244:247], v[112:115], v[172:175]
    ds_read_b128 v[120:123], v6 offset:1024
    v_mfma_f32_16x16x32_bf16 v[176:179], a[240:243], v[140:143], v[176:179]
    v_mfma_f32_16x16x32_bf16 v[180:183], a[244:247], v[140:143], v[180:183]
    ds_read_b128 v[116:119], v6 offset:2048
    s_waitcnt lgkmcnt(4)
    v_mfma_f32_16x16x32_bf16 v[184:187], a[240:243], v[136:139], v[184:187]
    v_mfma_f32_16x16x32_bf16 v[188:191], a[244:247], v[136:139], v[188:191]
    ds_read_b128 v[112:115], v6 offset:3072
    v_mfma_f32_16x16x32_bf16 v[192:195], a[240:243], v[132:135], v[192:195]
    v_mfma_f32_16x16x32_bf16 v[196:199], a[244:247], v[132:135], v[196:199]
    ds_read_b128 v[140:143], v6 offset:4096
    s_waitcnt lgkmcnt(4)
    v_mfma_f32_16x16x32_bf16 v[200:203], a[240:243], v[128:131], v[200:203]
    v_mfma_f32_16x16x32_bf16 v[204:207], a[244:247], v[128:131], v[204:207]
    ds_read_b128 v[136:139], v6 offset:5120
    v_mfma_f32_16x16x32_bf16 v[144:147], a[248:251], v[124:127], v[144:147]
    v_mfma_f32_16x16x32_bf16 v[148:151], a[252:255], v[124:127], v[148:151]
    ds_read_b128 v[132:135], v6 offset:6144
    s_waitcnt lgkmcnt(4)
    v_mfma_f32_16x16x32_bf16 v[152:155], a[248:251], v[120:123], v[152:155]
    v_mfma_f32_16x16x32_bf16 v[156:159], a[252:255], v[120:123], v[156:159]
    ds_read_b128 v[128:131], v6 offset:7168
    v_mfma_f32_16x16x32_bf16 v[160:163], a[248:251], v[116:119], v[160:163]
    v_mfma_f32_16x16x32_bf16 v[164:167], a[252:255], v[116:119], v[164:167]
    s_waitcnt vmcnt(8)
    s_barrier
    ds_read_b128 v[124:127], v6 offset:8192
    s_waitcnt lgkmcnt(4)
    v_mfma_f32_16x16x32_bf16 v[168:171], a[248:251], v[112:115], v[168:171]
    s_add_u32 m0, s6, 32768
    s_nop 0
    v_mfma_f32_16x16x32_bf16 v[172:175], a[252:255], v[112:115], v[172:175]
    ds_read_b128 v[120:123], v6 offset:9216
    v_mfma_f32_16x16x32_bf16 v[176:179], a[248:251], v[140:143], v[176:179]
    buffer_load_dwordx4 v18, s[40:43], s67 offen offset:0 sc1 lds
    v_mfma_f32_16x16x32_bf16 v[180:183], a[252:255], v[140:143], v[180:183]
    ds_read_b128 v[116:119], v6 offset:10240
    s_waitcnt lgkmcnt(4)
    v_mfma_f32_16x16x32_bf16 v[184:187], a[248:251], v[136:139], v[184:187]
    s_add_u32 m0, s6, 36864
    s_nop 0
    v_mfma_f32_16x16x32_bf16 v[188:191], a[252:255], v[136:139], v[188:191]
    ds_read_b128 v[112:115], v6 offset:11264
    v_mfma_f32_16x16x32_bf16 v[192:195], a[248:251], v[132:135], v[192:195]
    buffer_load_dwordx4 v18, s[40:43], s68 offen offset:0 sc1 lds
    v_mfma_f32_16x16x32_bf16 v[196:199], a[252:255], v[132:135], v[196:199]
    ds_read_b128 v[140:143], v6 offset:12288
    s_waitcnt lgkmcnt(4)
    v_mfma_f32_16x16x32_bf16 v[200:203], a[248:251], v[128:131], v[200:203]
    s_add_u32 m0, s6, 40960
    s_nop 0
    v_mfma_f32_16x16x32_bf16 v[204:207], a[252:255], v[128:131], v[204:207]
    ds_read_b128 v[136:139], v6 offset:13312
    v_mfma_f32_16x16x32_bf16 v[208:211], a[192:195], v[124:127], v[208:211]
    buffer_load_dwordx4 v18, s[40:43], s69 offen offset:0 sc1 lds
    v_mfma_f32_16x16x32_bf16 v[212:215], a[196:199], v[124:127], v[212:215]
    ds_read_b128 v[132:135], v6 offset:14336
    s_waitcnt lgkmcnt(4)
    v_mfma_f32_16x16x32_bf16 v[216:219], a[192:195], v[120:123], v[216:219]
    s_add_u32 m0, s6, 45056
    s_nop 0
    v_mfma_f32_16x16x32_bf16 v[220:223], a[196:199], v[120:123], v[220:223]
    ds_read_b128 v[128:131], v6 offset:15360
    v_mfma_f32_16x16x32_bf16 v[224:227], a[192:195], v[116:119], v[224:227]
    buffer_load_dwordx4 v18, s[40:43], s70 offen offset:0 sc1 lds
    v_mfma_f32_16x16x32_bf16 v[228:231], a[196:199], v[116:119], v[228:231]
    ds_read_b128 v[124:127], v6 offset:16384
    s_waitcnt lgkmcnt(4)
    v_mfma_f32_16x16x32_bf16 v[232:235], a[192:195], v[112:115], v[232:235]
    v_cvt_pk_bf16_f32 v32, v144, v152
    v_cvt_pk_bf16_f32 v33, v160, v168
    v_mfma_f32_16x16x32_bf16 v[236:239], a[196:199], v[112:115], v[236:239]
    ds_read_b128 v[120:123], v6 offset:17408
    v_mfma_f32_16x16x32_bf16 v[208:211], a[200:203], v[140:143], v[208:211]
    buffer_store_dwordx2 v[32:33], v10, s[36:39], 0 offen offset:0 nt
    v_mfma_f32_16x16x32_bf16 v[212:215], a[204:207], v[140:143], v[212:215]
    ds_read_b128 v[116:119], v6 offset:18432
    s_waitcnt lgkmcnt(4)
    v_mfma_f32_16x16x32_bf16 v[216:219], a[200:203], v[136:139], v[216:219]
    s_add_u32 m0, s6, 49152
    s_nop 0
    v_mfma_f32_16x16x32_bf16 v[220:223], a[204:207], v[136:139], v[220:223]
    ds_read_b128 v[112:115], v6 offset:19456
    v_mfma_f32_16x16x32_bf16 v[224:227], a[200:203], v[132:135], v[224:227]
    buffer_load_dwordx4 v18, s[40:43], s71 offen offset:0 sc1 lds
    v_mfma_f32_16x16x32_bf16 v[228:231], a[204:207], v[132:135], v[228:231]
    ds_read_b128 v[140:143], v6 offset:20480
    s_waitcnt lgkmcnt(4)
    v_mfma_f32_16x16x32_bf16 v[232:235], a[200:203], v[128:131], v[232:235]
    v_cvt_pk_bf16_f32 v34, v176, v184
    v_cvt_pk_bf16_f32 v35, v192, v200
    v_mfma_f32_16x16x32_bf16 v[236:239], a[204:207], v[128:131], v[236:239]
    ds_read_b128 v[136:139], v6 offset:21504
    v_mfma_f32_16x16x32_bf16 v[208:211], a[208:211], v[124:127], v[208:211]
    buffer_store_dwordx2 v[34:35], v10, s[36:39], 0 offen offset:128 nt
    v_mfma_f32_16x16x32_bf16 v[212:215], a[212:215], v[124:127], v[212:215]
    ds_read_b128 v[132:135], v6 offset:22528
    s_waitcnt lgkmcnt(4)
    v_mfma_f32_16x16x32_bf16 v[216:219], a[208:211], v[120:123], v[216:219]
    v_cvt_pk_bf16_f32 v36, v145, v153
    v_cvt_pk_bf16_f32 v37, v161, v169
    v_mfma_f32_16x16x32_bf16 v[220:223], a[212:215], v[120:123], v[220:223]
    ds_read_b128 v[128:131], v6 offset:23552
    s_mov_b32 s78, 7168
    v_mfma_f32_16x16x32_bf16 v[224:227], a[208:211], v[116:119], v[224:227]
    buffer_store_dwordx2 v[36:37], v10, s[36:39], s78 offen offset:0 nt
    v_mfma_f32_16x16x32_bf16 v[228:231], a[212:215], v[116:119], v[228:231]
    ds_read_b128 v[124:127], v6 offset:24576
    s_waitcnt lgkmcnt(4)
    v_mfma_f32_16x16x32_bf16 v[232:235], a[208:211], v[112:115], v[232:235]
    s_add_u32 m0, s6, 53248
    s_nop 0
    v_mfma_f32_16x16x32_bf16 v[236:239], a[212:215], v[112:115], v[236:239]
    ds_read_b128 v[120:123], v6 offset:25600
    v_mfma_f32_16x16x32_bf16 v[208:211], a[216:219], v[140:143], v[208:211]
    buffer_load_dwordx4 v18, s[40:43], s72 offen offset:0 sc1 lds
    v_mfma_f32_16x16x32_bf16 v[212:215], a[220:223], v[140:143], v[212:215]
    ds_read_b128 v[116:119], v6 offset:26624
    s_waitcnt lgkmcnt(4)
    v_mfma_f32_16x16x32_bf16 v[216:219], a[216:219], v[136:139], v[216:219]
    v_cvt_pk_bf16_f32 v38, v177, v185
    v_cvt_pk_bf16_f32 v39, v193, v201
    v_mfma_f32_16x16x32_bf16 v[220:223], a[220:223], v[136:139], v[220:223]
    ds_read_b128 v[112:115], v6 offset:27648
    v_mfma_f32_16x16x32_bf16 v[224:227], a[216:219], v[132:135], v[224:227]
    buffer_store_dwordx2 v[38:39], v10, s[36:39], s78 offen offset:128 nt
    v_mfma_f32_16x16x32_bf16 v[228:231], a[220:223], v[132:135], v[228:231]
    ds_read_b128 v[140:143], v6 offset:28672
    s_waitcnt lgkmcnt(4)
    v_mfma_f32_16x16x32_bf16 v[232:235], a[216:219], v[128:131], v[232:235]
    v_cvt_pk_bf16_f32 v40, v146, v154
    v_cvt_pk_bf16_f32 v41, v162, v170
    v_mfma_f32_16x16x32_bf16 v[236:239], a[220:223], v[128:131], v[236:239]
    ds_read_b128 v[136:139], v6 offset:29696
    s_mov_b32 s78, 14336
    v_mfma_f32_16x16x32_bf16 v[208:211], a[224:227], v[124:127], v[208:211]
    buffer_store_dwordx2 v[40:41], v10, s[36:39], s78 offen offset:0 nt
    v_mfma_f32_16x16x32_bf16 v[212:215], a[228:231], v[124:127], v[212:215]
    ds_read_b128 v[132:135], v6 offset:30720
    s_waitcnt lgkmcnt(4)
    v_mfma_f32_16x16x32_bf16 v[216:219], a[224:227], v[120:123], v[216:219]
    v_mfma_f32_16x16x32_bf16 v[220:223], a[228:231], v[120:123], v[220:223]
    ds_read_b128 v[128:131], v6 offset:31744
    v_cvt_pk_bf16_f32 v42, v178, v186
    v_mfma_f32_16x16x32_bf16 v[224:227], a[224:227], v[116:119], v[224:227]
    v_cvt_pk_bf16_f32 v43, v194, v202
    v_mfma_f32_16x16x32_bf16 v[228:231], a[228:231], v[116:119], v[228:231]
    s_waitcnt vmcnt(13)
    s_barrier
    ds_read_b128 v[124:127], v5 offset:0
    s_waitcnt lgkmcnt(4)
    v_mfma_f32_16x16x32_bf16 v[232:235], a[224:227], v[112:115], v[232:235]
    buffer_store_dwordx2 v[42:43], v10, s[36:39], s78 offen offset:128 nt
    v_mfma_f32_16x16x32_bf16 v[236:239], a[228:231], v[112:115], v[236:239]
    ds_read_b128 v[120:123], v5 offset:1024
    s_add_u32 m0, s6, 57344
    v_mfma_f32_16x16x32_bf16 v[208:211], a[232:235], v[140:143], v[208:211]
    s_nop 0
    v_mfma_f32_16x16x32_bf16 v[212:215], a[236:239], v[140:143], v[212:215]
    ds_read_b128 v[116:119], v5 offset:2048
    s_waitcnt lgkmcnt(4)
    v_mfma_f32_16x16x32_bf16 v[216:219], a[232:235], v[136:139], v[216:219]
    buffer_load_dwordx4 v18, s[40:43], s73 offen offset:0 sc1 lds
    v_mfma_f32_16x16x32_bf16 v[220:223], a[236:239], v[136:139], v[220:223]
    ds_read_b128 v[112:115], v5 offset:3072
    v_cvt_pk_bf16_f32 v44, v147, v155
    v_mfma_f32_16x16x32_bf16 v[224:227], a[232:235], v[132:135], v[224:227]
    v_cvt_pk_bf16_f32 v45, v163, v171
    s_mov_b32 s78, 21504
    v_mfma_f32_16x16x32_bf16 v[228:231], a[236:239], v[132:135], v[228:231]
    ds_read_b128 v[140:143], v5 offset:4096
    s_waitcnt lgkmcnt(4)
    v_mfma_f32_16x16x32_bf16 v[232:235], a[232:235], v[128:131], v[232:235]
    buffer_store_dwordx2 v[44:45], v10, s[36:39], s78 offen offset:0 nt
    v_mfma_f32_16x16x32_bf16 v[236:239], a[236:239], v[128:131], v[236:239]
    ds_read_b128 v[136:139], v5 offset:5120
    v_cvt_pk_bf16_f32 v46, v179, v187
    v_mfma_f32_16x16x32_bf16 v[208:211], a[240:243], v[124:127], v[208:211]
    v_cvt_pk_bf16_f32 v47, v195, v203
    v_mfma_f32_16x16x32_bf16 v[212:215], a[244:247], v[124:127], v[212:215]
    ds_read_b128 v[132:135], v5 offset:6144
    s_waitcnt lgkmcnt(4)
    v_mfma_f32_16x16x32_bf16 v[216:219], a[240:243], v[120:123], v[216:219]
    buffer_store_dwordx2 v[46:47], v10, s[36:39], s78 offen offset:128 nt
    v_mfma_f32_16x16x32_bf16 v[220:223], a[244:247], v[120:123], v[220:223]
    ds_read_b128 v[128:131], v5 offset:7168
    s_add_u32 m0, s6, 61440
    v_mfma_f32_16x16x32_bf16 v[224:227], a[240:243], v[116:119], v[224:227]
    s_nop 0
    v_mfma_f32_16x16x32_bf16 v[228:231], a[244:247], v[116:119], v[228:231]
    ds_read_b128 v[124:127], v5 offset:8192
    s_waitcnt lgkmcnt(4)
    v_mfma_f32_16x16x32_bf16 v[232:235], a[240:243], v[112:115], v[232:235]
    buffer_load_dwordx4 v18, s[40:43], s74 offen offset:0 sc1 lds
    v_mfma_f32_16x16x32_bf16 v[236:239], a[244:247], v[112:115], v[236:239]
    ds_read_b128 v[120:123], v5 offset:9216
    v_cvt_pk_bf16_f32 v32, v148, v156
    v_mfma_f32_16x16x32_bf16 v[208:211], a[248:251], v[140:143], v[208:211]
    v_cvt_pk_bf16_f32 v33, v164, v172
    s_mov_b32 s78, 114688
    v_mfma_f32_16x16x32_bf16 v[212:215], a[252:255], v[140:143], v[212:215]
    ds_read_b128 v[116:119], v5 offset:10240
    s_waitcnt lgkmcnt(4)
    v_mfma_f32_16x16x32_bf16 v[216:219], a[248:251], v[136:139], v[216:219]
    buffer_store_dwordx2 v[32:33], v10, s[36:39], s78 offen offset:0 nt
    v_mfma_f32_16x16x32_bf16 v[220:223], a[252:255], v[136:139], v[220:223]
    ds_read_b128 v[112:115], v5 offset:11264
    v_cvt_pk_bf16_f32 v34, v180, v188
    v_mfma_f32_16x16x32_bf16 v[224:227], a[248:251], v[132:135], v[224:227]
    v_cvt_pk_bf16_f32 v35, v196, v204
    v_mfma_f32_16x16x32_bf16 v[228:231], a[252:255], v[132:135], v[228:231]
    ds_read_b128 v[140:143], v5 offset:12288
    s_waitcnt lgkmcnt(4)
    v_mfma_f32_16x16x32_bf16 v[232:235], a[248:251], v[128:131], v[232:235]
    buffer_store_dwordx2 v[34:35], v10, s[36:39], s78 offen offset:128 nt
    v_mfma_f32_16x16x32_bf16 v[236:239], a[252:255], v[128:131], v[236:239]
    ds_read_b128 v[136:139], v5 offset:13312
    s_add_u32 m0, s6, 65536
    v_mfma_f32_16x16x32_bf16 v[240:243], a[16:19], v[124:127], v[240:243]
    s_nop 0
    v_mfma_f32_16x16x32_bf16 v[244:247], a[20:23], v[124:127], v[244:247]
    ds_read_b128 v[132:135], v5 offset:14336
    s_waitcnt lgkmcnt(4)
    v_mfma_f32_16x16x32_bf16 v[248:251], a[16:19], v[120:123], v[248:251]
    buffer_load_dwordx4 v18, s[40:43], s75 offen offset:0 sc1 lds
    v_mfma_f32_16x16x32_bf16 v[252:255], a[20:23], v[120:123], v[252:255]
    ds_read_b128 v[128:131], v5 offset:15360
    v_cvt_pk_bf16_f32 v36, v149, v157
    v_mfma_f32_16x16x32_bf16 v[240:243], a[24:27], v[116:119], v[240:243]
    v_cvt_pk_bf16_f32 v37, v165, v173
    s_mov_b32 s78, 121856
    v_mfma_f32_16x16x32_bf16 v[244:247], a[28:31], v[116:119], v[244:247]
    ds_read_b128 v[124:127], v5 offset:16384
    s_waitcnt lgkmcnt(4)
    v_mfma_f32_16x16x32_bf16 v[248:251], a[24:27], v[112:115], v[248:251]
    buffer_store_dwordx2 v[36:37], v10, s[36:39], s78 offen offset:0 nt
    v_mfma_f32_16x16x32_bf16 v[252:255], a[28:31], v[112:115], v[252:255]
    ds_read_b128 v[120:123], v5 offset:17408
    v_cvt_pk_bf16_f32 v38, v181, v189
    v_mfma_f32_16x16x32_bf16 v[240:243], a[32:35], v[140:143], v[240:243]
    v_cvt_pk_bf16_f32 v39, v197, v205
    v_mfma_f32_16x16x32_bf16 v[244:247], a[36:39], v[140:143], v[244:247]
    ds_read_b128 v[116:119], v5 offset:18432
    s_waitcnt lgkmcnt(4)
    v_mfma_f32_16x16x32_bf16 v[248:251], a[32:35], v[136:139], v[248:251]
    buffer_store_dwordx2 v[38:39], v10, s[36:39], s78 offen offset:128 nt
    v_mfma_f32_16x16x32_bf16 v[252:255], a[36:39], v[136:139], v[252:255]
    ds_read_b128 v[112:115], v5 offset:19456
    v_mfma_f32_16x16x32_bf16 v[240:243], a[40:43], v[132:135], v[240:243]
    v_mfma_f32_16x16x32_bf16 v[244:247], a[44:47], v[132:135], v[244:247]
    ds_read_b128 v[140:143], v5 offset:20480
    s_waitcnt lgkmcnt(4)
    v_mfma_f32_16x16x32_bf16 v[248:251], a[40:43], v[128:131], v[248:251]
    v_cvt_pk_bf16_f32 v40, v150, v158
    v_cvt_pk_bf16_f32 v41, v166, v174
    v_mfma_f32_16x16x32_bf16 v[252:255], a[44:47], v[128:131], v[252:255]
    ds_read_b128 v[136:139], v5 offset:21504
    s_mov_b32 s78, 129024
    v_mfma_f32_16x16x32_bf16 v[240:243], a[48:51], v[124:127], v[240:243]
    buffer_store_dwordx2 v[40:41], v10, s[36:39], s78 offen offset:0 nt
    v_mfma_f32_16x16x32_bf16 v[244:247], a[52:55], v[124:127], v[244:247]
    ds_read_b128 v[132:135], v5 offset:22528
    s_waitcnt lgkmcnt(4)
    v_mfma_f32_16x16x32_bf16 v[248:251], a[48:51], v[120:123], v[248:251]
    v_mfma_f32_16x16x32_bf16 v[252:255], a[52:55], v[120:123], v[252:255]
    ds_read_b128 v[128:131], v5 offset:23552
    v_cvt_pk_bf16_f32 v42, v182, v190
    v_mfma_f32_16x16x32_bf16 v[240:243], a[56:59], v[116:119], v[240:243]
    v_cvt_pk_bf16_f32 v43, v198, v206
    v_mfma_f32_16x16x32_bf16 v[244:247], a[60:63], v[116:119], v[244:247]
    s_waitcnt vmcnt(18)
    s_barrier
    ds_read_b128 v[124:127], v5 offset:24576
    s_waitcnt lgkmcnt(4)
    v_mfma_f32_16x16x32_bf16 v[248:251], a[56:59], v[112:115], v[248:251]
    buffer_store_dwordx2 v[42:43], v10, s[36:39], s78 offen offset:128 nt
    v_mfma_f32_16x16x32_bf16 v[252:255], a[60:63], v[112:115], v[252:255]
    ds_read_b128 v[120:123], v5 offset:25600
    v_mfma_f32_16x16x32_bf16 v[240:243], a[64:67], v[140:143], v[240:243]
    v_mfma_f32_16x16x32_bf16 v[244:247], a[68:71], v[140:143], v[244:247]
    ds_read_b128 v[116:119], v5 offset:26624
    s_waitcnt lgkmcnt(4)
    v_mfma_f32_16x16x32_bf16 v[248:251], a[64:67], v[136:139], v[248:251]
    v_cvt_pk_bf16_f32 v44, v151, v159
    v_cvt_pk_bf16_f32 v45, v167, v175
    v_mfma_f32_16x16x32_bf16 v[252:255], a[68:71], v[136:139], v[252:255]
    ds_read_b128 v[112:115], v5 offset:27648
    s_mov_b32 s78, 136192
    v_mfma_f32_16x16x32_bf16 v[240:243], a[72:75], v[132:135], v[240:243]
    buffer_store_dwordx2 v[44:45], v10, s[36:39], s78 offen offset:0 nt
    v_mfma_f32_16x16x32_bf16 v[244:247], a[76:79], v[132:135], v[244:247]
    ds_read_b128 v[140:143], v5 offset:28672
    s_waitcnt lgkmcnt(4)
    v_mfma_f32_16x16x32_bf16 v[248:251], a[72:75], v[128:131], v[248:251]
    v_mfma_f32_16x16x32_bf16 v[252:255], a[76:79], v[128:131], v[252:255]
    ds_read_b128 v[136:139], v5 offset:29696
    v_cvt_pk_bf16_f32 v46, v183, v191
    v_mfma_f32_16x16x32_bf16 v[240:243], a[80:83], v[124:127], v[240:243]
    v_cvt_pk_bf16_f32 v47, v199, v207
    v_mfma_f32_16x16x32_bf16 v[244:247], a[84:87], v[124:127], v[244:247]
    ds_read_b128 v[132:135], v5 offset:30720
    s_waitcnt lgkmcnt(4)
    v_mfma_f32_16x16x32_bf16 v[248:251], a[80:83], v[120:123], v[248:251]
    buffer_store_dwordx2 v[46:47], v10, s[36:39], s78 offen offset:128 nt
    v_mfma_f32_16x16x32_bf16 v[252:255], a[84:87], v[120:123], v[252:255]
    ds_read_b128 v[128:131], v5 offset:31744
    v_mfma_f32_16x16x32_bf16 v[240:243], a[88:91], v[116:119], v[240:243]
    v_mfma_f32_16x16x32_bf16 v[244:247], a[92:95], v[116:119], v[244:247]
    ds_read_b128 v[124:127], v5 offset:32768
    s_waitcnt lgkmcnt(4)
    v_mfma_f32_16x16x32_bf16 v[248:251], a[88:91], v[112:115], v[248:251]
    v_cvt_pk_bf16_f32 v32, v208, v216
    v_mfma_f32_16x16x32_bf16 v[252:255], a[92:95], v[112:115], v[252:255]
    ds_read_b128 v[120:123], v5 offset:33792
    v_mfma_f32_16x16x32_bf16 v[240:243], a[96:99], v[140:143], v[240:243]
    buffer_store_dword v32, v11, s[36:39], 0 offen offset:0 nt
    v_mfma_f32_16x16x32_bf16 v[244:247], a[100:103], v[140:143], v[244:247]
    ds_read_b128 v[116:119], v5 offset:34816
    s_waitcnt lgkmcnt(4)
    v_mfma_f32_16x16x32_bf16 v[248:251], a[96:99], v[136:139], v[248:251]
    v_mfma_f32_16x16x32_bf16 v[252:255], a[100:103], v[136:139], v[252:255]
    ds_read_b128 v[112:115], v5 offset:35840
    v_cvt_pk_bf16_f32 v34, v224, v232
    v_mfma_f32_16x16x32_bf16 v[240:243], a[104:107], v[132:135], v[240:243]
    buffer_store_dword v34, v11, s[36:39], 0 offen offset:64 nt
    v_mfma_f32_16x16x32_bf16 v[244:247], a[108:111], v[132:135], v[244:247]
    ds_read_b128 v[140:143], v5 offset:36864
    s_waitcnt lgkmcnt(4)
    v_mfma_f32_16x16x32_bf16 v[248:251], a[104:107], v[128:131], v[248:251]
    v_mfma_f32_16x16x32_bf16 v[252:255], a[108:111], v[128:131], v[252:255]
    ds_read_b128 v[136:139], v5 offset:37888
    v_mfma_f32_16x16x32_bf16 v[240:243], a[112:115], v[124:127], v[240:243]
    v_mfma_f32_16x16x32_bf16 v[244:247], a[116:119], v[124:127], v[244:247]
    ds_read_b128 v[132:135], v5 offset:38912
    s_waitcnt lgkmcnt(4)
    v_mfma_f32_16x16x32_bf16 v[248:251], a[112:115], v[120:123], v[248:251]
    v_cvt_pk_bf16_f32 v36, v209, v217
    s_mov_b32 s78, 7168
    v_mfma_f32_16x16x32_bf16 v[252:255], a[116:119], v[120:123], v[252:255]
    ds_read_b128 v[128:131], v5 offset:39936
    v_mfma_f32_16x16x32_bf16 v[240:243], a[120:123], v[116:119], v[240:243]
    buffer_store_dword v36, v11, s[36:39], s78 offen offset:0 nt
    v_mfma_f32_16x16x32_bf16 v[244:247], a[124:127], v[116:119], v[244:247]
    ds_read_b128 v[124:127], v5 offset:40960
    s_waitcnt lgkmcnt(4)
    v_mfma_f32_16x16x32_bf16 v[248:251], a[120:123], v[112:115], v[248:251]
    v_mfma_f32_16x16x32_bf16 v[252:255], a[124:127], v[112:115], v[252:255]
    ds_read_b128 v[120:123], v5 offset:41984
    v_cvt_pk_bf16_f32 v38, v225, v233
    v_mfma_f32_16x16x32_bf16 v[240:243], a[128:131], v[140:143], v[240:243]
    buffer_store_dword v38, v11, s[36:39], s78 offen offset:64 nt
    v_mfma_f32_16x16x32_bf16 v[244:247], a[132:135], v[140:143], v[244:247]
    ds_read_b128 v[116:119], v5 offset:43008
    s_waitcnt lgkmcnt(4)
    v_mfma_f32_16x16x32_bf16 v[248:251], a[128:131], v[136:139], v[248:251]
    v_mfma_f32_16x16x32_bf16 v[252:255], a[132:135], v[136:139], v[252:255]
    ds_read_b128 v[112:115], v5 offset:44032
    v_mfma_f32_16x16x32_bf16 v[240:243], a[136:139], v[132:135], v[240:243]
    v_mfma_f32_16x16x32_bf16 v[244:247], a[140:143], v[132:135], v[244:247]
    ds_read_b128 v[140:143], v5 offset:45056
    s_waitcnt lgkmcnt(4)
    v_mfma_f32_16x16x32_bf16 v[248:251], a[136:139], v[128:131], v[248:251]
    v_cvt_pk_bf16_f32 v40, v210, v218
    s_mov_b32 s78, 14336
    v_mfma_f32_16x16x32_bf16 v[252:255], a[140:143], v[128:131], v[252:255]
    ds_read_b128 v[136:139], v5 offset:46080
L_pad5:
    s_cbranch_execz L_back
    v_mfma_f32_16x16x32_bf16 v[240:243], a[144:147], v[124:127], v[240:243]
    buffer_store_dword v40, v11, s[36:39], s78 offen offset:0 nt
    v_mfma_f32_16x16x32_bf16 v[244:247], a[148:151], v[124:127], v[244:247]
    ds_read_b128 v[132:135], v5 offset:47104
    s_waitcnt lgkmcnt(4)
    v_mfma_f32_16x16x32_bf16 v[248:251], a[144:147], v[120:123], v[248:251]
    v_mfma_f32_16x16x32_bf16 v[252:255], a[148:151], v[120:123], v[252:255]
    ds_read_b128 v[128:131], v5 offset:48128
    v_cvt_pk_bf16_f32 v42, v226, v234
    v_mfma_f32_16x16x32_bf16 v[240:243], a[152:155], v[116:119], v[240:243]
    buffer_store_dword v42, v11, s[36:39], s78 offen offset:64 nt
    v_mfma_f32_16x16x32_bf16 v[244:247], a[156:159], v[116:119], v[244:247]
    s_waitcnt vmcnt(12)
    s_barrier
    ds_read_b128 v[124:127], v5 offset:49152
    s_waitcnt lgkmcnt(4)
    v_mfma_f32_16x16x32_bf16 v[248:251], a[152:155], v[112:115], v[248:251]
    v_mfma_f32_16x16x32_bf16 v[252:255], a[156:159], v[112:115], v[252:255]
    ds_read_b128 v[120:123], v5 offset:50176
    v_mfma_f32_16x16x32_bf16 v[240:243], a[160:163], v[140:143], v[240:243]
    v_mfma_f32_16x16x32_bf16 v[244:247], a[164:167], v[140:143], v[244:247]
    ds_read_b128 v[116:119], v5 offset:51200
    s_waitcnt lgkmcnt(4)
    v_mfma_f32_16x16x32_bf16 v[248:251], a[160:163], v[136:139], v[248:251]
    v_cvt_pk_bf16_f32 v44, v211, v219
    s_mov_b32 s78, 21504
    v_mfma_f32_16x16x32_bf16 v[252:255], a[164:167], v[136:139], v[252:255]
    ds_read_b128 v[112:115], v5 offset:52224
    v_mfma_f32_16x16x32_bf16 v[240:243], a[168:171], v[132:135], v[240:243]
    buffer_store_dword v44, v11, s[36:39], s78 offen offset:0 nt
    v_mfma_f32_16x16x32_bf16 v[244:247], a[172:175], v[132:135], v[244:247]
    ds_read_b128 v[140:143], v5 offset:53248
    s_waitcnt lgkmcnt(4)
    v_mfma_f32_16x16x32_bf16 v[248:251], a[168:171], v[128:131], v[248:251]
    v_mfma_f32_16x16x32_bf16 v[252:255], a[172:175], v[128:131], v[252:255]
    ds_read_b128 v[136:139], v5 offset:54272
    v_cvt_pk_bf16_f32 v46, v227, v235
    v_mfma_f32_16x16x32_bf16 v[240:243], a[176:179], v[124:127], v[240:243]
    buffer_store_dword v46, v11, s[36:39], s78 offen offset:64 nt
    v_mfma_f32_16x16x32_bf16 v[244:247], a[180:183], v[124:127], v[244:247]
    ds_read_b128 v[132:135], v5 offset:55296
    s_waitcnt lgkmcnt(4)
    v_mfma_f32_16x16x32_bf16 v[248:251], a[176:179], v[120:123], v[248:251]
    v_mfma_f32_16x16x32_bf16 v[252:255], a[180:183], v[120:123], v[252:255]
    ds_read_b128 v[128:131], v5 offset:56320
    v_mfma_f32_16x16x32_bf16 v[240:243], a[184:187], v[116:119], v[240:243]
    v_mfma_f32_16x16x32_bf16 v[244:247], a[188:191], v[116:119], v[244:247]
    ds_read_b128 v[124:127], v5 offset:57344
    s_waitcnt lgkmcnt(4)
    v_mfma_f32_16x16x32_bf16 v[248:251], a[184:187], v[112:115], v[248:251]
    v_cvt_pk_bf16_f32 v32, v212, v220
    s_mov_b32 s78, 114688
    v_mfma_f32_16x16x32_bf16 v[252:255], a[188:191], v[112:115], v[252:255]
    ds_read_b128 v[120:123], v5 offset:58368
    v_mfma_f32_16x16x32_bf16 v[240:243], a[192:195], v[140:143], v[240:243]
    buffer_store_dword v32, v11, s[36:39], s78 offen offset:0 nt
    v_mfma_f32_16x16x32_bf16 v[244:247], a[196:199], v[140:143], v[244:247]
    ds_read_b128 v[116:119], v5 offset:59392
    s_waitcnt lgkmcnt(4)
    v_mfma_f32_16x16x32_bf16 v[248:251], a[192:195], v[136:139], v[248:251]
    v_mfma_f32_16x16x32_bf16 v[252:255], a[196:199], v[136:139], v[252:255]
    ds_read_b128 v[112:115], v5 offset:60416
    v_cvt_pk_bf16_f32 v34, v228, v236
    v_mfma_f32_16x16x32_bf16 v[240:243], a[200:203], v[132:135], v[240:243]
    buffer_store_dword v34, v11, s[36:39], s78 offen offset:64 nt
    v_mfma_f32_16x16x32_bf16 v[244:247], a[204:207], v[132:135], v[244:247]
    ds_read_b128 v[140:143], v5 offset:61440
    s_waitcnt lgkmcnt(4)
    v_mfma_f32_16x16x32_bf16 v[248:251], a[200:203], v[128:131], v[248:251]
    v_mfma_f32_16x16x32_bf16 v[252:255], a[204:207], v[128:131], v[252:255]
    ds_read_b128 v[136:139], v5 offset:62464
    v_mfma_f32_16x16x32_bf16 v[240:243], a[208:211], v[124:127], v[240:243]
    v_mfma_f32_16x16x32_bf16 v[244:247], a[212:215], v[124:127], v[244:247]
    ds_read_b128 v[132:135], v5 offset:63488
    s_waitcnt lgkmcnt(4)
    v_mfma_f32_16x16x32_bf16 v[248:251], a[208:211], v[120:123], v[248:251]
    v_cvt_pk_bf16_f32 v36, v213, v221
    s_mov_b32 s78, 121856
    v_mfma_f32_16x16x32_bf16 v[252:255], a[212:215], v[120:123], v[252:255]
    ds_read_b128 v[128:131], v5 offset:64512
    v_mfma_f32_16x16x32_bf16 v[240:243], a[216:219], v[116:119], v[240:243]
    buffer_store_dword v36, v11, s[36:39], s78 offen offset:0 nt
    v_mfma_f32_16x16x32_bf16 v[244:247], a[220:223], v[116:119], v[244:247]
    ds_read_b128 v[124:127], v6 offset:0
    s_waitcnt lgkmcnt(4)
    v_mfma_f32_16x16x32_bf16 v[248:251], a[216:219], v[112:115], v[248:251]
    v_mfma_f32_16x16x32_bf16 v[252:255], a[220:223], v[112:115], v[252:255]
    ds_read_b128 v[120:123], v6 offset:1024
    v_cvt_pk_bf16_f32 v38, v229, v237
    v_mfma_f32_16x16x32_bf16 v[240:243], a[224:227], v[140:143], v[240:243]
    buffer_store_dword v38, v11, s[36:39], s78 offen offset:64 nt
    v_mfma_f32_16x16x32_bf16 v[244:247], a[228:231], v[140:143], v[244:247]
    ds_read_b128 v[116:119], v6 offset:2048
    s_waitcnt lgkmcnt(4)
    v_mfma_f32_16x16x32_bf16 v[248:251], a[224:227], v[136:139], v[248:251]
    v_mfma_f32_16x16x32_bf16 v[252:255], a[228:231], v[136:139], v[252:255]
    ds_read_b128 v[112:115], v6 offset:3072
    v_mfma_f32_16x16x32_bf16 v[240:243], a[232:235], v[132:135], v[240:243]
    v_mfma_f32_16x16x32_bf16 v[244:247], a[236:239], v[132:135], v[244:247]
    v_cvt_pk_bf16_f32 v40, v214, v222
    s_waitcnt lgkmcnt(3)
    v_mfma_f32_16x16x32_bf16 v[248:251], a[232:235], v[128:131], v[248:251]
    s_mov_b32 s78, 129024
    v_mfma_f32_16x16x32_bf16 v[252:255], a[236:239], v[128:131], v[252:255]
    buffer_store_dword v40, v11, s[36:39], s78 offen offset:0 nt
    v_mfma_f32_16x16x32_bf16 v[240:243], a[240:243], v[124:127], v[240:243]
    v_mfma_f32_16x16x32_bf16 v[244:247], a[244:247], v[124:127], v[244:247]
    s_waitcnt lgkmcnt(1)
    v_mfma_f32_16x16x32_bf16 v[248:251], a[240:243], v[120:123], v[248:251]
    v_mfma_f32_16x16x32_bf16 v[252:255], a[244:247], v[120:123], v[252:255]
    v_cvt_pk_bf16_f32 v42, v230, v238
    v_mfma_f32_16x16x32_bf16 v[240:243], a[248:251], v[116:119], v[240:243]
    buffer_store_dword v42, v11, s[36:39], s78 offen offset:64 nt
    v_mfma_f32_16x16x32_bf16 v[244:247], a[252:255], v[116:119], v[244:247]
    s_waitcnt lgkmcnt(0)
    v_mfma_f32_16x16x32_bf16 v[248:251], a[248:251], v[112:115], v[248:251]
    v_mfma_f32_16x16x32_bf16 v[252:255], a[252:255], v[112:115], v[252:255]
    v_cvt_pk_bf16_f32 v44, v215, v223
    s_mov_b32 s78, 136192
    buffer_store_dword v44, v11, s[36:39], s78 offen offset:0 nt
    v_cvt_pk_bf16_f32 v46, v231, v239
    buffer_store_dword v46, v11, s[36:39], s78 offen offset:64 nt
    s_nop 3
    v_cvt_pk_bf16_f32 v32, v240, v248
    buffer_store_dword v32, v22, s[36:39], 0 offen offset:0 nt
    v_cvt_pk_bf16_f32 v34, v241, v249
    s_mov_b32 s78, 7168
    buffer_store_dword v34, v22, s[36:39], s78 offen offset:0 nt
    v_cvt_pk_bf16_f32 v36, v242, v250
    s_mov_b32 s78, 14336
    buffer_store_dword v36, v22, s[36:39], s78 offen offset:0 nt
    v_cvt_pk_bf16_f32 v38, v243, v251
    s_mov_b32 s78, 21504
    buffer_store_dword v38, v22, s[36:39], s78 offen offset:0 nt
    v_cvt_pk_bf16_f32 v40, v244, v252
    s_mov_b32 s78, 114688
    buffer_store_dword v40, v22, s[36:39], s78 offen offset:0 nt
    v_cvt_pk_bf16_f32 v42, v245, v253
    s_mov_b32 s78, 121856
    buffer_store_dword v42, v22, s[36:39], s78 offen offset:0 nt
    v_cvt_pk_bf16_f32 v44, v246, v254
    s_mov_b32 s78, 129024
    buffer_store_dword v44, v22, s[36:39], s78 offen offset:0 nt
    v_cvt_pk_bf16_f32 v46, v247, v255
    s_mov_b32 s78, 136192
    buffer_store_dword v46, v22, s[36:39], s78 offen offset:0 nt
L_end:
    s_endpgm
L_slow:
    s_lshl_b32 s79, s60, 2
    s_add_u32 s79, s79, 20971520
    buffer_store_dwordx4 v[32:35], v16, s[40:43], s79 offen offset:0 sc1
    buffer_store_dwordx4 v[40:43], v16, s[40:43], s79 offen offset:1024 sc1
    buffer_store_dwordx4 v[48:51], v16, s[40:43], s79 offen offset:2048 sc1
    buffer_store_dwordx4 v[56:59], v16, s[40:43], s79 offen offset:3072 sc1
    s_waitcnt vmcnt(0)
    buffer_store_dwordx2 v[2:3], v7, s[40:43], 0 offen offset:512 sc1
    s_mov_b32 s3, 131072
    s_lshr_b32 s52, s55, 4
L_poll_g:
    s_sub_u32 s3, s3, 1
    s_cbranch_scc1 L_ok_l
    buffer_load_dwordx2 v[62:63], v23, s[40:43], 0 offen offset:0 sc1
    s_waitcnt vmcnt(0)
    v_cmp_eq_u64 vcc, s[54:55], v[62:63]
    s_or_b64 s[58:59], vcc, s[56:57]
    s_cmp_eq_u64 s[58:59], -1
    s_cbranch_scc1 L_ok_l
    buffer_load_dwordx2 v[62:63], v23, s[40:43], 0 offen offset:512 sc1
    s_waitcnt vmcnt(0)
    v_cmp_eq_u64 vcc, s[54:55], v[62:63]
    s_or_b64 s[58:59], vcc, s[56:57]
    s_cmp_eq_u64 s[58:59], -1
    s_cbranch_scc1 L_ok_l
    v_lshrrev_b32 v63, 4, v63
    v_cmp_eq_u32 vcc, s54, v62
    s_mov_b64 s[58:59], vcc
    v_cmp_eq_u32 vcc, s52, v63
    s_and_b64 s[58:59], s[58:59], vcc
    s_or_b64 s[58:59], s[58:59], s[56:57]
    s_cmp_eq_u64 s[58:59], -1
    s_cbranch_scc0 L_poll_g
    v_add_u32 v16, 20971520, v16
    v_add_u32 v17, 20971520, v17
    v_add_u32 v18, 20971520, v18
    s_mov_b32 s11, 1
    s_branch L_ok_l
L_far_stb:
    s_lshl_b32 s79, s60, 1
    buffer_store_dwordx4 v[64:67], v17, s[40:43], s79 offen offset:0 sc1
    buffer_store_dwordx4 v[72:75], v17, s[40:43], s79 offen offset:1024 sc1
    buffer_store_dwordx4 v[80:83], v18, s[40:43], s60 offen offset:0 sc1
    s_branch L_near_stb
L_far_flb:
    buffer_store_dwordx2 v[2:3], v7, s[40:43], 0 offen offset:1024 sc1
    s_branch L_near_flb
.section .rodata,"a"
.p2align 6
.amdhsa_kernel standalone__normalfloat_lut_codebook_lookup__prompt_kernel
  .amdhsa_next_free_vgpr 512
  .amdhsa_next_free_sgpr 102
  .amdhsa_accum_offset 256
  .amdhsa_group_segment_fixed_size 0
  .amdhsa_kernarg_size 56
  .amdhsa_user_sgpr_count 2
  .amdhsa_user_sgpr_kernarg_segment_ptr 1
  .amdhsa_system_sgpr_workgroup_id_x 1
  .amdhsa_float_denorm_mode_32 3
.end_amdhsa_kernel
```
